```python
import torch

def _softmax(x, axis=-1):
    return torch.softmax(x, dim=axis)
def _gelu(x):
    return torch.nn.functional.gelu(x, approximate="tanh")
def _silu(x):
    return torch.nn.functional.silu(x)
def _sigmoid(x):
    return torch.sigmoid(x)
def _layernorm(x, axis=-1, eps=1e-5):
    m = x.mean(dim=axis, keepdim=True)
    v = x.var(dim=axis, keepdim=True, unbiased=False)
    return (x - m) / torch.sqrt(v + eps)
def _scatter_add(tgt, idx, src, axis=0):
    return tgt.clone().index_add_(axis, idx, src)
def _segment_sum(src, seg, n):
    out = torch.zeros((n,) + src.shape[1:], dtype=src.dtype)
    return out.index_add_(0, seg, src)
def _pad(x, pw):
    flat = tuple(v for pair in reversed(pw) for v in pair)
    return torch.nn.functional.pad(x, flat)

kernel_name = 'recurrent_scan__gqa_block_cached__mixer_token_mlp__decode'

def setup_inputs():

    _w = (lambda a: (lambda t: t.to(torch.bfloat16) if t.is_floating_point() else t)(torch.as_tensor(a)))
    def _A_setup():
        B, Sq, D = 4, 1, 576
        Hq, Hkv, Sk, Dh = 32, 16, 8192, 128
        assert Hq % Hkv == 0, (Hq, Hkv)
        return {
            "x": _w((lambda *s: torch.randn(*s, dtype=torch.bfloat16) * 0.05)(B, Sq, D)),
            "k_cache": _w((lambda *s: torch.randn(*s, dtype=torch.bfloat16) * 1.6)(B, Hkv, Sk, Dh)),
            "v_cache": _w((lambda *s: torch.randn(*s, dtype=torch.bfloat16) * 1.6)(B, Hkv, Sk, Dh)),
            "wq": _w((lambda *s: torch.randn(*s, dtype=torch.bfloat16) * 1.6)(D, Hq * Dh) * (D ** -0.5)),
            "wo": _w((lambda *s: torch.randn(*s, dtype=torch.bfloat16) * 1.6)(Hq * Dh, D) * ((Hq * Dh) ** -0.5)),
        }
    _A_in = _A_setup()

    def _B_setup():
        B, S, D, F = 4, 1, 576, 4608
        return {
            "x": _w((lambda *s: torch.randn(*s, dtype=torch.bfloat16) * 0.05)(B, S, D)),
            "w1": _w((lambda *s: torch.randn(*s, dtype=torch.bfloat16) * 0.2)(S, F) * (S ** -0.5)),
            "b1": _w((lambda *s: torch.randn(*s, dtype=torch.bfloat16) * 0.2)(F) * 0.02),
            "w2": _w((lambda *s: torch.randn(*s, dtype=torch.bfloat16) * 0.2)(F, S) * (F ** -0.5)),
            "b2": _w((lambda *s: torch.randn(*s, dtype=torch.bfloat16) * 0.2)(S) * 0.02),
        }
    _B_in = _B_setup()

    return {
        "A_x": _A_in["x"],
        "A_k_cache": _A_in["k_cache"],
        "A_v_cache": _A_in["v_cache"],
        "A_wq": _A_in["wq"],
        "A_wo": _A_in["wo"],
        "B_x": _B_in["x"],
        "B_w1": _B_in["w1"],
        "B_b1": _B_in["b1"],
        "B_w2": _B_in["w2"],
        "B_b2": _B_in["b2"],
    }

def reference(A_x, A_k_cache, A_v_cache, A_wq, A_wo, B_x, B_w1, B_b1, B_w2, B_b2):
    def _A_ref(x, k_cache, v_cache, wq, wo):
        B, Sq, D = x.shape
        Hq, Dh = 32, 128
        Hkv = k_cache.shape[1]
        rep = Hq // Hkv
        q = (lambda x, *d: x.permute(*d))((x @ wq).reshape(B, Sq, Hq, Dh), 0, 2, 1, 3)
        k = (lambda x, n, axis: torch.repeat_interleave(x, n, dim=axis))(k_cache, rep, axis=1)
        v = (lambda x, n, axis: torch.repeat_interleave(x, n, dim=axis))(v_cache, rep, axis=1)
        scores = torch.einsum("bhqd,bhkd->bhqk", q, k) * (Dh ** -0.5)
        p = _softmax(scores, axis=-1)
        o = torch.einsum("bhqk,bhkd->bhqd", p, v)
        return (lambda x, *d: x.permute(*d))(o, 0, 2, 1, 3).reshape(B, Sq, Hq * Dh) @ wo

    def _B_ref(x, w1, b1, w2, b2):
        B, S, D = x.shape
        h = _layernorm(x, axis=-1)
        u = torch.einsum("bsd,sf->bdf", h, w1) + b1
        u = _gelu(u)
        y = torch.einsum("bdf,fs->bds", u, w2) + b2
        return (lambda x, *d: x.permute(*d))(y, 0, 2, 1)

    x = A_x
    xn = _layernorm(x, axis=-1)
    s = _A_ref(xn, A_k_cache, A_v_cache, A_wq, A_wo)
    g = _silu(_B_ref(xn, B_w1, B_b1, B_w2, B_b2))
    return x + s * g
```

```asm
; @launch grid=(256,1,1) block=(512,1,1) lds=155648
.amdgcn_target "amdgcn-amd-amdhsa--gfx950"
.text
.globl recurrent_scan__gqa_block_cached__mixer_token_mlp__decode_kernel
.p2align 8
.type recurrent_scan__gqa_block_cached__mixer_token_mlp__decode_kernel,@function
recurrent_scan__gqa_block_cached__mixer_token_mlp__decode_kernel:
  s_cmp_ge_u32 s2, 256
  s_cbranch_scc1 L_exit
  s_load_dwordx2 s[44:45], s[0:1], 8
  s_load_dwordx2 s[48:49], s[0:1], 16
  s_load_dwordx2 s[52:53], s[0:1], 0
  s_load_dwordx2 s[56:57], s[0:1], 24
  s_load_dwordx2 s[60:61], s[0:1], 32
  s_load_dwordx2 s[64:65], s[0:1], 48
  s_load_dwordx2 s[68:69], s[0:1], 56
  s_load_dwordx2 s[72:73], s[0:1], 64
  s_load_dwordx2 s[76:77], s[0:1], 72
  s_load_dwordx2 s[80:81], s[0:1], 80
  s_load_dwordx2 s[84:85], s[0:1], 88
  s_load_dwordx2 s[88:89], s[0:1], 96
  v_and_b32 v1, 63, v0
  v_lshrrev_b32 v4, 6, v0
  s_nop 0
  v_readfirstlane_b32 s3, v4
  s_and_b32 s4, s2, 15
  s_bfe_u32 s5, s2, 0x20004
  s_lshr_b32 s6, s2, 6
  s_lshl_b32 s7, s4, 2
  s_add_u32 s7, s7, s6
  s_lshl_b32 s2, s5, 6
  s_add_u32 s2, s2, s7
  v_and_b32 v4, 3, v1
  v_lshlrev_b32 v2, 4, v4
  v_bfe_u32 v4, v1, 2, 2
  v_lshl_add_u32 v2, v4, 8, v2
  v_lshrrev_b32 v4, 4, v1
  v_lshl_add_u32 v2, v4, 6, v2
  s_lshl_b32 s8, s2, 19
  s_lshl_b32 s9, s3, 12
  s_add_u32 s8, s8, s9
  s_mov_b32 s46, 0x8000000
  s_mov_b32 s47, 0x20000
  s_add_u32 s9, s8, 32768
  s_waitcnt lgkmcnt(0)
  buffer_load_dwordx4 v[116:119], v2, s[44:47], s8 offen offset:0 nt
  buffer_load_dwordx4 v[120:123], v2, s[44:47], s8 offen offset:1024 nt
  buffer_load_dwordx4 v[124:127], v2, s[44:47], s8 offen offset:2048 nt
  buffer_load_dwordx4 v[128:131], v2, s[44:47], s8 offen offset:3072 nt
  v_lshlrev_b32 v3, 4, v1
  s_mov_b32 s10, 0x05040100
  s_mov_b32 s11, 0x07060302
  s_mov_b32 s12, 0xaaaaaaaa
  s_mov_b32 s13, 0xaaaaaaaa
  s_mov_b32 s14, 0xcccccccc
  s_mov_b32 s15, 0xcccccccc
  s_lshl_b32 s8, s2, 19
  s_lshl_b32 s9, s3, 12
  s_add_u32 s8, s8, s9
  s_mul_i32 s42, s3, 9216
  s_mov_b32 s46, 134217728
  s_mov_b32 s47, 0x20000
  s_mov_b32 s50, 134217728
  s_mov_b32 s51, 0x20000
  s_mov_b32 s54, 4608
  s_mov_b32 s55, 0x20000
  s_mov_b32 s58, 4718592
  s_mov_b32 s59, 0x20000
  s_mov_b32 s62, 4718592
  s_mov_b32 s63, 0x20000
  s_mov_b32 s66, 9216
  s_mov_b32 s67, 0x20000
  s_mov_b32 s70, 9216
  s_mov_b32 s71, 0x20000
  s_mov_b32 s74, 9216
  s_mov_b32 s75, 0x20000
  s_mov_b32 s78, 2
  s_mov_b32 s79, 0x20000
  s_mov_b32 s82, 4608
  s_mov_b32 s83, 0x20000
  s_mov_b32 s86, 256
  s_mov_b32 s87, 0x20000
  s_mov_b32 s90, 4194304
  s_mov_b32 s91, 0x20000
  s_lshl_b32 s43, s4, 4
  s_lshl_b32 s9, s5, 2
  s_add_u32 s43, s43, s9
  s_add_u32 s43, s43, s6
  s_mul_i32 s41, s3, 6144
  s_cmp_lt_u32 s3, 4
  s_cbranch_scc1 L_noprio
  s_setprio 2
L_noprio:
  s_nop 7
  s_cmp_ge_u32 s3, 4
  s_cbranch_scc1 L_role_wq
  s_mul_i32 s9, s3, 1152
  v_lshlrev_b32 v4, 1, v1
  s_waitcnt lgkmcnt(0)
  buffer_load_ushort v196, v4, s[52:55], s9 offen offset:0
  buffer_load_ushort v197, v4, s[52:55], s9 offen offset:128
  buffer_load_ushort v198, v4, s[52:55], s9 offen offset:256
  buffer_load_ushort v199, v4, s[52:55], s9 offen offset:384
  buffer_load_ushort v200, v4, s[52:55], s9 offen offset:512
  buffer_load_ushort v201, v4, s[52:55], s9 offen offset:640
  buffer_load_ushort v202, v4, s[52:55], s9 offen offset:768
  buffer_load_ushort v203, v4, s[52:55], s9 offen offset:896
  buffer_load_ushort v204, v4, s[52:55], s9 offen offset:1024
  s_branch L_role_done
L_role_wq:
  s_nop 7
  s_cmp_eq_u32 s3, 7
  s_cbranch_scc1 L_role_init
  s_and_b32 s92, s43, 7
  s_sub_u32 s93, s3, 4
  s_lshl_b32 s93, s93, 3
  s_add_u32 s93, s93, s92
  s_cmp_ge_u32 s93, 18
  s_cbranch_scc1 L_role_done
  v_lshrrev_b32 v4, 4, v1
  v_lshlrev_b32 v4, 16, v4
  v_and_b32 v5, 15, v1
  v_lshl_add_u32 v4, v5, 4, v4
  s_lshl_b32 s9, s93, 18
  s_lshr_b32 s95, s43, 3
  s_lshl_b32 s95, s95, 8
  s_add_u32 s9, s9, s95
  s_waitcnt lgkmcnt(0)
  buffer_load_dwordx4 v[228:231], v4, s[56:59], s9 offen nt
  s_add_u32 s9, s9, 8192
  buffer_load_dwordx4 v[232:235], v4, s[56:59], s9 offen nt
  s_add_u32 s9, s9, 8192
  buffer_load_dwordx4 v[236:239], v4, s[56:59], s9 offen nt
  s_add_u32 s9, s9, 8192
  buffer_load_dwordx4 v[240:243], v4, s[56:59], s9 offen nt
  s_add_u32 s9, s9, 8192
  buffer_load_dwordx4 v[244:247], v4, s[56:59], s9 offen nt
  s_add_u32 s9, s9, 8192
  buffer_load_dwordx4 v[248:251], v4, s[56:59], s9 offen nt
  s_add_u32 s9, s9, 8192
  buffer_load_dwordx4 v[192:195], v4, s[56:59], s9 offen nt
  s_add_u32 s9, s9, 8192
  buffer_load_dwordx4 v[188:191], v4, s[56:59], s9 offen nt
  s_branch L_role_done
L_role_init:
  s_nop 7
  v_mov_b32 v176, -1
  v_mov_b32 v177, -1
  v_mov_b32 v178, -1
  v_mov_b32 v179, -1
  s_lshl_b32 s9, s43, 11
  s_waitcnt lgkmcnt(0)
  buffer_store_dwordx4 v[176:179], v3, s[88:91], s9 offen sc0 sc1
  buffer_store_dwordx4 v[176:179], v3, s[88:91], s9 offen offset:1024 sc0 sc1
  s_lshl_b32 s9, s2, 11
  s_add_u32 s9, s9, 524288
  buffer_store_dwordx4 v[176:179], v3, s[88:91], s9 offen sc0 sc1
  buffer_store_dwordx4 v[176:179], v3, s[88:91], s9 offen offset:1024 sc0 sc1
  s_mov_b64 exec, -1
  s_mul_i32 s9, s2, 2304
  s_add_u32 s9, s9, 1048576
  buffer_store_dwordx4 v[176:179], v3, s[88:91], s9 offen sc0 sc1
  buffer_store_dwordx4 v[176:179], v3, s[88:91], s9 offen offset:1024 sc0 sc1
  s_mov_b64 exec, 0xffff
  buffer_store_dwordx4 v[176:179], v3, s[88:91], s9 offen offset:2048 sc0 sc1
  s_mul_i32 s9, s2, 36
  s_add_u32 s9, s9, 1703936
  v_lshlrev_b32 v4, 2, v1
  s_mov_b64 exec, 0x1ff
  buffer_store_dword v176, v4, s[88:91], s9 offen sc0 sc1
  s_mov_b64 exec, -1
  v_mov_b32 v4, 104448
  v_mov_b32 v6, 0
  v_mov_b32 v7, 0
  ds_write_b64 v4, v[6:7]
L_role_done:
  s_nop 7
  s_waitcnt lgkmcnt(0)
  s_add_u32 s9, s8, 32768
  buffer_load_dwordx4 v[132:135], v2, s[44:47], s9 offen offset:0 nt
  s_add_u32 s9, s8, 32768
  buffer_load_dwordx4 v[136:139], v2, s[44:47], s9 offen offset:1024 nt
  s_add_u32 s9, s8, 32768
  buffer_load_dwordx4 v[140:143], v2, s[44:47], s9 offen offset:2048 nt
  s_add_u32 s9, s8, 32768
  buffer_load_dwordx4 v[144:147], v2, s[44:47], s9 offen offset:3072 nt
  s_waitcnt vmcnt(4)
  s_add_u32 s9, s8, 65536
  buffer_load_dwordx4 v[148:151], v2, s[44:47], s9 offen offset:0 nt
  s_add_u32 s9, s8, 65536
  buffer_load_dwordx4 v[152:155], v2, s[44:47], s9 offen offset:1024 nt
  s_add_u32 s9, s8, 65536
  buffer_load_dwordx4 v[156:159], v2, s[44:47], s9 offen offset:2048 nt
  s_add_u32 s9, s8, 65536
  buffer_load_dwordx4 v[160:163], v2, s[44:47], s9 offen offset:3072 nt
  s_cmp_ge_u32 s3, 4
  s_cbranch_scc1 L_ln_done
  v_lshlrev_b32 v196, 16, v196
  v_lshlrev_b32 v197, 16, v197
  v_lshlrev_b32 v198, 16, v198
  v_lshlrev_b32 v199, 16, v199
  v_lshlrev_b32 v200, 16, v200
  v_lshlrev_b32 v201, 16, v201
  v_lshlrev_b32 v202, 16, v202
  v_lshlrev_b32 v203, 16, v203
  v_lshlrev_b32 v204, 16, v204
  v_add_f32 v205, v196, v197
  v_add_f32 v205, v205, v198
  v_add_f32 v205, v205, v199
  v_add_f32 v205, v205, v200
  v_add_f32 v205, v205, v201
  v_add_f32 v205, v205, v202
  v_add_f32 v205, v205, v203
  v_add_f32 v205, v205, v204
  s_nop 1
  v_add_f32_dpp v205, v205, v205 quad_perm:[1,0,3,2] row_mask:0xf bank_mask:0xf
  s_nop 1
  v_add_f32_dpp v205, v205, v205 quad_perm:[2,3,0,1] row_mask:0xf bank_mask:0xf
  s_nop 1
  v_add_f32_dpp v205, v205, v205 row_half_mirror row_mask:0xf bank_mask:0xf
  s_nop 1
  v_add_f32_dpp v205, v205, v205 row_mirror row_mask:0xf bank_mask:0xf
  v_mov_b32 v206, v205
  s_nop 1
  v_permlane16_swap_b32 v206, v205
  v_add_f32 v205, v205, v206
  v_mov_b32 v206, v205
  s_nop 1
  v_permlane32_swap_b32 v206, v205
  v_add_f32 v205, v205, v206
  v_mul_f32 v205, 0x3ae38e39, v205
  v_sub_f32 v207, v196, v205
  v_mul_f32 v208, v207, v207
  v_sub_f32 v207, v197, v205
  v_fmac_f32 v208, v207, v207
  v_sub_f32 v207, v198, v205
  v_fmac_f32 v208, v207, v207
  v_sub_f32 v207, v199, v205
  v_fmac_f32 v208, v207, v207
  v_sub_f32 v207, v200, v205
  v_fmac_f32 v208, v207, v207
  v_sub_f32 v207, v201, v205
  v_fmac_f32 v208, v207, v207
  v_sub_f32 v207, v202, v205
  v_fmac_f32 v208, v207, v207
  v_sub_f32 v207, v203, v205
  v_fmac_f32 v208, v207, v207
  v_sub_f32 v207, v204, v205
  v_fmac_f32 v208, v207, v207
  s_nop 1
  v_add_f32_dpp v208, v208, v208 quad_perm:[1,0,3,2] row_mask:0xf bank_mask:0xf
  s_nop 1
  v_add_f32_dpp v208, v208, v208 quad_perm:[2,3,0,1] row_mask:0xf bank_mask:0xf
  s_nop 1
  v_add_f32_dpp v208, v208, v208 row_half_mirror row_mask:0xf bank_mask:0xf
  s_nop 1
  v_add_f32_dpp v208, v208, v208 row_mirror row_mask:0xf bank_mask:0xf
  v_mov_b32 v206, v208
  s_nop 1
  v_permlane16_swap_b32 v206, v208
  v_add_f32 v208, v208, v206
  v_mov_b32 v206, v208
  s_nop 1
  v_permlane32_swap_b32 v206, v208
  v_add_f32 v208, v208, v206
  v_mul_f32 v208, 0x3ae38e39, v208
  v_cvt_pk_bf16_f32 v208, v208, v208
  v_lshlrev_b32 v208, 16, v208
  v_cvt_pk_bf16_f32 v205, v205, v205
  v_lshlrev_b32 v205, 16, v205
  v_add_f32 v208, 0x3727c5ac, v208
  v_cvt_pk_bf16_f32 v208, v208, v208
  v_lshlrev_b32 v208, 16, v208
  v_sqrt_f32 v208, v208
  s_nop 0
  v_cvt_pk_bf16_f32 v208, v208, v208
  v_lshlrev_b32 v208, 16, v208
  v_rcp_f32 v209, v208
  v_sub_f32 v196, v196, v205
  v_sub_f32 v197, v197, v205
  v_sub_f32 v198, v198, v205
  v_sub_f32 v199, v199, v205
  v_sub_f32 v200, v200, v205
  v_sub_f32 v201, v201, v205
  v_sub_f32 v202, v202, v205
  v_sub_f32 v203, v203, v205
  v_sub_f32 v204, v204, v205
  v_cvt_pk_bf16_f32 v196, v196, v196
  v_cvt_pk_bf16_f32 v197, v197, v197
  v_cvt_pk_bf16_f32 v198, v198, v198
  v_cvt_pk_bf16_f32 v199, v199, v199
  v_cvt_pk_bf16_f32 v200, v200, v200
  v_cvt_pk_bf16_f32 v201, v201, v201
  v_cvt_pk_bf16_f32 v202, v202, v202
  v_cvt_pk_bf16_f32 v203, v203, v203
  v_cvt_pk_bf16_f32 v204, v204, v204
  v_lshlrev_b32 v196, 16, v196
  v_lshlrev_b32 v197, 16, v197
  v_lshlrev_b32 v198, 16, v198
  v_lshlrev_b32 v199, 16, v199
  v_lshlrev_b32 v200, 16, v200
  v_lshlrev_b32 v201, 16, v201
  v_lshlrev_b32 v202, 16, v202
  v_lshlrev_b32 v203, 16, v203
  v_lshlrev_b32 v204, 16, v204
  v_mul_f32 v210, v196, v209
  v_fma_f32 v211, -v210, v208, v196
  v_fma_f32 v196, v211, v209, v210
  v_mul_f32 v210, v197, v209
  v_fma_f32 v211, -v210, v208, v197
  v_fma_f32 v197, v211, v209, v210
  v_mul_f32 v210, v198, v209
  v_fma_f32 v211, -v210, v208, v198
  v_fma_f32 v198, v211, v209, v210
  v_mul_f32 v210, v199, v209
  v_fma_f32 v211, -v210, v208, v199
  v_fma_f32 v199, v211, v209, v210
  v_mul_f32 v210, v200, v209
  v_fma_f32 v211, -v210, v208, v200
  v_fma_f32 v200, v211, v209, v210
  v_mul_f32 v210, v201, v209
  v_fma_f32 v211, -v210, v208, v201
  v_fma_f32 v201, v211, v209, v210
  v_mul_f32 v210, v202, v209
  v_fma_f32 v211, -v210, v208, v202
  v_fma_f32 v202, v211, v209, v210
  v_mul_f32 v210, v203, v209
  v_fma_f32 v211, -v210, v208, v203
  v_fma_f32 v203, v211, v209, v210
  v_mul_f32 v210, v204, v209
  v_fma_f32 v211, -v210, v208, v204
  v_fma_f32 v204, v211, v209, v210
  v_cvt_pk_bf16_f32 v196, v196, v196
  v_cvt_pk_bf16_f32 v197, v197, v197
  v_cvt_pk_bf16_f32 v198, v198, v198
  v_cvt_pk_bf16_f32 v199, v199, v199
  v_cvt_pk_bf16_f32 v200, v200, v200
  v_cvt_pk_bf16_f32 v201, v201, v201
  v_cvt_pk_bf16_f32 v202, v202, v202
  v_cvt_pk_bf16_f32 v203, v203, v203
  v_cvt_pk_bf16_f32 v204, v204, v204
  v_lshlrev_b32 v196, 16, v196
  v_lshlrev_b32 v197, 16, v197
  v_lshlrev_b32 v198, 16, v198
  v_lshlrev_b32 v199, 16, v199
  v_lshlrev_b32 v200, 16, v200
  v_lshlrev_b32 v201, 16, v201
  v_lshlrev_b32 v202, 16, v202
  v_lshlrev_b32 v203, 16, v203
  v_lshlrev_b32 v204, 16, v204
  s_mul_i32 s9, s3, 1152
  s_add_u32 s9, s9, 73728
  v_lshl_add_u32 v4, v1, 1, s9
  ds_write_b16_d16_hi v4, v196 offset:0
  ds_write_b16_d16_hi v4, v197 offset:128
  ds_write_b16_d16_hi v4, v198 offset:256
  ds_write_b16_d16_hi v4, v199 offset:384
  ds_write_b16_d16_hi v4, v200 offset:512
  ds_write_b16_d16_hi v4, v201 offset:640
  ds_write_b16_d16_hi v4, v202 offset:768
  ds_write_b16_d16_hi v4, v203 offset:896
  ds_write_b16_d16_hi v4, v204 offset:1024
L_ln_done:
  s_nop 7
  s_waitcnt lgkmcnt(0)
  s_barrier
  s_waitcnt vmcnt(4)
  s_add_u32 s9, s8, 98304
  buffer_load_dwordx4 v[164:167], v2, s[44:47], s9 offen offset:0 nt
  s_add_u32 s9, s8, 98304
  buffer_load_dwordx4 v[168:171], v2, s[44:47], s9 offen offset:1024 nt
  s_add_u32 s9, s8, 98304
  buffer_load_dwordx4 v[172:175], v2, s[44:47], s9 offen offset:2048 nt
  s_add_u32 s9, s8, 98304
  buffer_load_dwordx4 v[16:19], v2, s[44:47], s9 offen offset:3072 nt
  s_cmp_lt_u32 s3, 4
  s_cbranch_scc1 L_qp_done
  s_cmp_eq_u32 s3, 7
  s_cbranch_scc1 L_comm
  s_cmp_lt_u32 s93, 18
  s_cbranch_scc1 L_qp_do
  v_mov_b32 v228, 0
  v_mov_b32 v229, 0
  v_mov_b32 v230, 0
  v_mov_b32 v231, 0
  v_mov_b32 v232, 0
  v_mov_b32 v233, 0
  v_mov_b32 v234, 0
  v_mov_b32 v235, 0
  s_branch L_qp_write
L_qp_do:
  s_nop 7
  v_and_b32 v4, 3, v1
  v_mul_u32_u24 v4, 1152, v4
  v_lshrrev_b32 v5, 4, v1
  v_lshl_add_u32 v4, v5, 4, v4
  s_lshl_b32 s9, s93, 6
  s_add_u32 s9, s9, 73728
  v_add_u32 v4, s9, v4
  ds_read_b128 v[176:179], v4
  s_waitcnt lgkmcnt(0)
  v_perm_b32 v180, v232, v228, s10
  v_perm_b32 v181, v240, v236, s10
  v_perm_b32 v182, v248, v244, s10
  v_perm_b32 v183, v188, v192, s10
  s_nop 1
  v_mfma_f32_16x16x32_bf16 v[196:199], v[176:179], v[180:183], 0
  v_perm_b32 v184, v232, v228, s11
  v_perm_b32 v185, v240, v236, s11
  v_perm_b32 v186, v248, v244, s11
  v_perm_b32 v187, v188, v192, s11
  s_nop 1
  v_mfma_f32_16x16x32_bf16 v[200:203], v[176:179], v[184:187], 0
  v_perm_b32 v180, v233, v229, s10
  v_perm_b32 v181, v241, v237, s10
  v_perm_b32 v182, v249, v245, s10
  v_perm_b32 v183, v189, v193, s10
  s_nop 1
  v_mfma_f32_16x16x32_bf16 v[204:207], v[176:179], v[180:183], 0
  v_perm_b32 v184, v233, v229, s11
  v_perm_b32 v185, v241, v237, s11
  v_perm_b32 v186, v249, v245, s11
  v_perm_b32 v187, v189, v193, s11
  s_nop 1
  v_mfma_f32_16x16x32_bf16 v[208:211], v[176:179], v[184:187], 0
  v_perm_b32 v180, v234, v230, s10
  v_perm_b32 v181, v242, v238, s10
  v_perm_b32 v182, v250, v246, s10
  v_perm_b32 v183, v190, v194, s10
  s_nop 1
  v_mfma_f32_16x16x32_bf16 v[212:215], v[176:179], v[180:183], 0
  v_perm_b32 v184, v234, v230, s11
  v_perm_b32 v185, v242, v238, s11
  v_perm_b32 v186, v250, v246, s11
  v_perm_b32 v187, v190, v194, s11
  s_nop 1
  v_mfma_f32_16x16x32_bf16 v[216:219], v[176:179], v[184:187], 0
  v_perm_b32 v180, v235, v231, s10
  v_perm_b32 v181, v243, v239, s10
  v_perm_b32 v182, v251, v247, s10
  v_perm_b32 v183, v191, v195, s10
  s_nop 1
  v_mfma_f32_16x16x32_bf16 v[220:223], v[176:179], v[180:183], 0
  v_perm_b32 v184, v235, v231, s11
  v_perm_b32 v185, v243, v239, s11
  v_perm_b32 v186, v251, v247, s11
  v_perm_b32 v187, v191, v195, s11
  s_nop 1
  v_mfma_f32_16x16x32_bf16 v[224:227], v[176:179], v[184:187], 0
  s_mov_b32 s96, 0xffff0000
  s_mov_b32 s97, 0xffff0000
  s_mov_b32 s98, 0
  s_mov_b32 s99, 0xffffffff
  v_cndmask_b32 v196, v196, v197, s[96:97]
  v_cndmask_b32 v198, v198, v199, s[96:97]
  v_cndmask_b32 v228, v196, v198, s[98:99]
  v_cndmask_b32 v200, v200, v201, s[96:97]
  v_cndmask_b32 v202, v202, v203, s[96:97]
  v_cndmask_b32 v229, v200, v202, s[98:99]
  v_cndmask_b32 v204, v204, v205, s[96:97]
  v_cndmask_b32 v206, v206, v207, s[96:97]
  v_cndmask_b32 v230, v204, v206, s[98:99]
  v_cndmask_b32 v208, v208, v209, s[96:97]
  v_cndmask_b32 v210, v210, v211, s[96:97]
  v_cndmask_b32 v231, v208, v210, s[98:99]
  v_cndmask_b32 v212, v212, v213, s[96:97]
  v_cndmask_b32 v214, v214, v215, s[96:97]
  v_cndmask_b32 v232, v212, v214, s[98:99]
  v_cndmask_b32 v216, v216, v217, s[96:97]
  v_cndmask_b32 v218, v218, v219, s[96:97]
  v_cndmask_b32 v233, v216, v218, s[98:99]
  v_cndmask_b32 v220, v220, v221, s[96:97]
  v_cndmask_b32 v222, v222, v223, s[96:97]
  v_cndmask_b32 v234, v220, v222, s[98:99]
  v_cndmask_b32 v224, v224, v225, s[96:97]
  v_cndmask_b32 v226, v226, v227, s[96:97]
  v_cndmask_b32 v235, v224, v226, s[98:99]
L_qp_write:
  s_nop 7
  s_sub_u32 s9, s3, 4
  s_lshl_b32 s9, s9, 11
  s_add_u32 s9, s9, 80640
  v_lshl_add_u32 v4, v1, 5, s9
  ds_write_b128 v4, v[228:231]
  ds_write_b128 v4, v[232:235] offset:16
  v_mov_b32 v4, 104448
  v_mov_b32 v5, 1
  s_waitcnt lgkmcnt(0)
  s_mov_b64 exec, 1
  ds_add_u32 v4, v5
  s_mov_b64 exec, -1
  s_branch L_qp_done
L_comm:
  s_nop 7
  v_mov_b32 v5, 0
  v_mov_b32 v6, 1
  s_mov_b64 exec, 1
  buffer_store_byte v6, v5, s[84:87], s43 offen sc0 sc1
  s_mov_b64 exec, -1
  v_mov_b32 v4, 104448
  s_mov_b32 s94, 0
L_qc_spin:
  s_nop 7
  ds_read_b32 v5, v4
  s_waitcnt lgkmcnt(0)
  v_readfirstlane_b32 s95, v5
  s_nop 1
  s_cmp_eq_u32 s95, 3
  s_cbranch_scc1 L_qc_done
  s_add_u32 s94, s94, 1
  s_cmp_gt_u32 s94, 1600000
  s_cbranch_scc1 L_qc_done
  s_branch L_qc_spin
L_qc_done:
  s_nop 7
  v_mov_b32 v5, 80640
  v_lshl_add_u32 v4, v1, 5, v5
  ds_read_b128 v[196:199], v4 offset:0
  ds_read_b128 v[200:203], v4 offset:16
  ds_read_b128 v[204:207], v4 offset:2048
  ds_read_b128 v[208:211], v4 offset:2064
  ds_read_b128 v[212:215], v4 offset:4096
  ds_read_b128 v[216:219], v4 offset:4112
  s_waitcnt lgkmcnt(0)
  v_add_f32 v196, v196, v204
  v_add_f32 v197, v197, v205
  v_add_f32 v198, v198, v206
  v_add_f32 v199, v199, v207
  v_add_f32 v200, v200, v208
  v_add_f32 v201, v201, v209
  v_add_f32 v202, v202, v210
  v_add_f32 v203, v203, v211
  v_add_f32 v176, v196, v212
  v_add_f32 v177, v197, v213
  v_add_f32 v178, v198, v214
  v_add_f32 v179, v199, v215
  v_add_f32 v180, v200, v216
  v_add_f32 v181, v201, v217
  v_add_f32 v182, v202, v218
  v_add_f32 v183, v203, v219
  s_lshl_b32 s9, s43, 11
  v_lshlrev_b32 v4, 5, v1
  buffer_store_dwordx4 v[176:179], v4, s[88:91], s9 offen sc0 sc1
  buffer_store_dwordx4 v[180:183], v4, s[88:91], s9 offen offset:16 sc0 sc1
L_qp_done:
  s_nop 7
  v_lshlrev_b32 v4, 4, v0
  v_lshlrev_b32 v5, 1, v0
  v_add_u32 v5, 8192, v5
  v_mov_b32 v6, 0
  buffer_load_dwordx4 v[196:199], v4, s[64:67], 0 offen
  buffer_load_dwordx4 v[200:203], v4, s[68:71], 0 offen
  buffer_load_dwordx4 v[204:207], v4, s[72:75], 0 offen
  buffer_load_ushort v208, v5, s[64:67], 0 offen
  buffer_load_ushort v209, v5, s[68:71], 0 offen
  buffer_load_ushort v210, v5, s[72:75], 0 offen
  buffer_load_ushort v14, v6, s[76:79], 0 offen
  v_mov_b32 v214, 0
  v_mov_b32 v215, 0
  v_mov_b32 v216, 0
  v_mov_b32 v217, 0
  v_mov_b32 v218, 0
  v_mov_b32 v219, 0
  v_mov_b32 v220, 0
  v_mov_b32 v221, 0
  v_mov_b32 v222, 0
  v_mov_b32 v13, 0xbdd2d3e8
  v_lshrrev_b32 v4, 5, v1
  v_lshlrev_b32 v4, 14, v4
  v_and_b32 v5, 31, v1
  v_lshl_add_u32 v10, v5, 4, v4
  v_lshlrev_b32 v9, 2, v1
  s_lshl_b32 s40, s4, 15
  s_lshl_b32 s95, s3, 11
  s_add_u32 s40, s40, s95
  s_lshl_b32 s95, s5, 9
  s_add_u32 s40, s40, s95
  s_lshl_b32 s9, s4, 2
  s_lshl_b64 s[38:39], 15, s9
  s_mov_b32 s37, 0
  s_mov_b32 s36, 0
  s_waitcnt vmcnt(14)
  s_add_u32 s9, s8, 131072
  buffer_load_dwordx4 v[20:23], v2, s[44:47], s9 offen offset:0 nt
  s_waitcnt vmcnt(14)
  s_add_u32 s9, s8, 131072
  buffer_load_dwordx4 v[24:27], v2, s[44:47], s9 offen offset:1024 nt
  s_mul_i32 s9, s5, 1152
  s_add_u32 s9, s9, 73728
  v_lshl_add_u32 v4, v1, 1, s9
  ds_read_u16 v223, v4 offset:0
  ds_read_u16 v224, v4 offset:128
  ds_read_u16 v225, v4 offset:256
  ds_read_u16 v226, v4 offset:384
  ds_read_u16 v227, v4 offset:512
  ds_read_u16 v228, v4 offset:640
  ds_read_u16 v229, v4 offset:768
  ds_read_u16 v230, v4 offset:896
  ds_read_u16 v231, v4 offset:1024
  s_waitcnt lgkmcnt(0)
  v_lshlrev_b32 v223, 16, v223
  v_lshlrev_b32 v224, 16, v224
  v_lshlrev_b32 v225, 16, v225
  v_lshlrev_b32 v226, 16, v226
  v_lshlrev_b32 v227, 16, v227
  v_lshlrev_b32 v228, 16, v228
  v_lshlrev_b32 v229, 16, v229
  v_lshlrev_b32 v230, 16, v230
  v_lshlrev_b32 v231, 16, v231
  v_add_f32 v232, v223, v224
  v_add_f32 v232, v232, v225
  v_add_f32 v232, v232, v226
  v_add_f32 v232, v232, v227
  v_add_f32 v232, v232, v228
  v_add_f32 v232, v232, v229
  v_add_f32 v232, v232, v230
  v_add_f32 v232, v232, v231
  s_nop 1
  v_add_f32_dpp v232, v232, v232 quad_perm:[1,0,3,2] row_mask:0xf bank_mask:0xf
  s_nop 1
  v_add_f32_dpp v232, v232, v232 quad_perm:[2,3,0,1] row_mask:0xf bank_mask:0xf
  s_nop 1
  v_add_f32_dpp v232, v232, v232 row_half_mirror row_mask:0xf bank_mask:0xf
  s_nop 1
  v_add_f32_dpp v232, v232, v232 row_mirror row_mask:0xf bank_mask:0xf
  v_mov_b32 v233, v232
  s_nop 1
  v_permlane16_swap_b32 v233, v232
  v_add_f32 v232, v232, v233
  v_mov_b32 v233, v232
  s_nop 1
  v_permlane32_swap_b32 v233, v232
  v_add_f32 v232, v232, v233
  v_mul_f32 v232, 0x3ae38e39, v232
  v_sub_f32 v234, v223, v232
  v_mul_f32 v235, v234, v234
  v_sub_f32 v234, v224, v232
  v_fmac_f32 v235, v234, v234
  v_sub_f32 v234, v225, v232
  v_fmac_f32 v235, v234, v234
  v_sub_f32 v234, v226, v232
  v_fmac_f32 v235, v234, v234
  v_sub_f32 v234, v227, v232
  v_fmac_f32 v235, v234, v234
  v_sub_f32 v234, v228, v232
  v_fmac_f32 v235, v234, v234
  v_sub_f32 v234, v229, v232
  v_fmac_f32 v235, v234, v234
  v_sub_f32 v234, v230, v232
  v_fmac_f32 v235, v234, v234
  v_sub_f32 v234, v231, v232
  v_fmac_f32 v235, v234, v234
  s_nop 1
  v_add_f32_dpp v235, v235, v235 quad_perm:[1,0,3,2] row_mask:0xf bank_mask:0xf
  s_nop 1
  v_add_f32_dpp v235, v235, v235 quad_perm:[2,3,0,1] row_mask:0xf bank_mask:0xf
  s_nop 1
  v_add_f32_dpp v235, v235, v235 row_half_mirror row_mask:0xf bank_mask:0xf
  s_nop 1
  v_add_f32_dpp v235, v235, v235 row_mirror row_mask:0xf bank_mask:0xf
  v_mov_b32 v233, v235
  s_nop 1
  v_permlane16_swap_b32 v233, v235
  v_add_f32 v235, v235, v233
  v_mov_b32 v233, v235
  s_nop 1
  v_permlane32_swap_b32 v233, v235
  v_add_f32 v235, v235, v233
  v_mul_f32 v235, 0x3ae38e39, v235
  v_cvt_pk_bf16_f32 v235, v235, v235
  v_lshlrev_b32 v235, 16, v235
  v_cvt_pk_bf16_f32 v232, v232, v232
  v_lshlrev_b32 v232, 16, v232
  v_add_f32 v235, 0x3727c5ac, v235
  v_cvt_pk_bf16_f32 v235, v235, v235
  v_lshlrev_b32 v235, 16, v235
  v_sqrt_f32 v235, v235
  s_nop 0
  v_cvt_pk_bf16_f32 v235, v235, v235
  v_lshlrev_b32 v235, 16, v235
  v_rcp_f32 v236, v235
  v_sub_f32 v223, v223, v232
  v_sub_f32 v224, v224, v232
  v_sub_f32 v225, v225, v232
  v_sub_f32 v226, v226, v232
  v_sub_f32 v227, v227, v232
  v_sub_f32 v228, v228, v232
  v_sub_f32 v229, v229, v232
  v_sub_f32 v230, v230, v232
  v_sub_f32 v231, v231, v232
  v_cvt_pk_bf16_f32 v223, v223, v223
  v_cvt_pk_bf16_f32 v224, v224, v224
  v_cvt_pk_bf16_f32 v225, v225, v225
  v_cvt_pk_bf16_f32 v226, v226, v226
  v_cvt_pk_bf16_f32 v227, v227, v227
  v_cvt_pk_bf16_f32 v228, v228, v228
  v_cvt_pk_bf16_f32 v229, v229, v229
  v_cvt_pk_bf16_f32 v230, v230, v230
  v_cvt_pk_bf16_f32 v231, v231, v231
  v_lshlrev_b32 v223, 16, v223
  v_lshlrev_b32 v224, 16, v224
  v_lshlrev_b32 v225, 16, v225
  v_lshlrev_b32 v226, 16, v226
  v_lshlrev_b32 v227, 16, v227
  v_lshlrev_b32 v228, 16, v228
  v_lshlrev_b32 v229, 16, v229
  v_lshlrev_b32 v230, 16, v230
  v_lshlrev_b32 v231, 16, v231
  v_mul_f32 v237, v223, v236
  v_fma_f32 v238, -v237, v235, v223
  v_fma_f32 v223, v238, v236, v237
  v_mul_f32 v237, v224, v236
  v_fma_f32 v238, -v237, v235, v224
  v_fma_f32 v224, v238, v236, v237
  v_mul_f32 v237, v225, v236
  v_fma_f32 v238, -v237, v235, v225
  v_fma_f32 v225, v238, v236, v237
  v_mul_f32 v237, v226, v236
  v_fma_f32 v238, -v237, v235, v226
  v_fma_f32 v226, v238, v236, v237
  v_mul_f32 v237, v227, v236
  v_fma_f32 v238, -v237, v235, v227
  v_fma_f32 v227, v238, v236, v237
  v_mul_f32 v237, v228, v236
  v_fma_f32 v238, -v237, v235, v228
  v_fma_f32 v228, v238, v236, v237
  v_mul_f32 v237, v229, v236
  v_fma_f32 v238, -v237, v235, v229
  v_fma_f32 v229, v238, v236, v237
  v_mul_f32 v237, v230, v236
  v_fma_f32 v238, -v237, v235, v230
  v_fma_f32 v230, v238, v236, v237
  v_mul_f32 v237, v231, v236
  v_fma_f32 v238, -v237, v235, v231
  v_fma_f32 v231, v238, v236, v237
  v_cvt_pk_bf16_f32 v223, v223, v223
  v_cvt_pk_bf16_f32 v224, v224, v224
  v_cvt_pk_bf16_f32 v225, v225, v225
  v_cvt_pk_bf16_f32 v226, v226, v226
  v_cvt_pk_bf16_f32 v227, v227, v227
  v_cvt_pk_bf16_f32 v228, v228, v228
  v_cvt_pk_bf16_f32 v229, v229, v229
  v_cvt_pk_bf16_f32 v230, v230, v230
  v_cvt_pk_bf16_f32 v231, v231, v231
  v_lshlrev_b32 v223, 16, v223
  v_lshlrev_b32 v224, 16, v224
  v_lshlrev_b32 v225, 16, v225
  v_lshlrev_b32 v226, 16, v226
  v_lshlrev_b32 v227, 16, v227
  v_lshlrev_b32 v228, 16, v228
  v_lshlrev_b32 v229, 16, v229
  v_lshlrev_b32 v230, 16, v230
  v_lshlrev_b32 v231, 16, v231
  v_mov_b32 v5, 78336
  v_lshl_add_u32 v4, v1, 2, v5
  ds_write_b32 v4, v223 offset:0
  ds_write_b32 v4, v224 offset:256
  ds_write_b32 v4, v225 offset:512
  ds_write_b32 v4, v226 offset:768
  ds_write_b32 v4, v227 offset:1024
  ds_write_b32 v4, v228 offset:1280
  ds_write_b32 v4, v229 offset:1536
  ds_write_b32 v4, v230 offset:1792
  ds_write_b32 v4, v231 offset:2048
  s_mul_i32 s9, s7, 36
  s_add_u32 s9, s9, 78336
  v_mov_b32 v4, s9
  s_waitcnt lgkmcnt(0)
  ds_read_b32 v223, v4 offset:0
  ds_read_b32 v224, v4 offset:4
  ds_read_b32 v225, v4 offset:8
  ds_read_b32 v226, v4 offset:12
  ds_read_b32 v227, v4 offset:16
  ds_read_b32 v228, v4 offset:20
  ds_read_b32 v229, v4 offset:24
  ds_read_b32 v230, v4 offset:28
  ds_read_b32 v231, v4 offset:32
  s_waitcnt lgkmcnt(0)
  v_readfirstlane_b32 s16, v223
  v_readfirstlane_b32 s17, v224
  v_readfirstlane_b32 s18, v225
  v_readfirstlane_b32 s19, v226
  v_readfirstlane_b32 s20, v227
  v_readfirstlane_b32 s21, v228
  v_readfirstlane_b32 s22, v229
  v_readfirstlane_b32 s23, v230
  v_readfirstlane_b32 s24, v231
  s_waitcnt vmcnt(14)
  s_add_u32 s9, s8, 131072
  buffer_load_dwordx4 v[28:31], v2, s[44:47], s9 offen offset:2048 nt
  s_waitcnt vmcnt(14)
  s_add_u32 s9, s8, 131072
  buffer_load_dwordx4 v[32:35], v2, s[44:47], s9 offen offset:3072 nt
  s_barrier
  s_waitcnt vmcnt(14)
  s_add_u32 s9, s8, 163840
  buffer_load_dwordx4 v[36:39], v2, s[44:47], s9 offen offset:0 nt
  s_waitcnt vmcnt(14)
  s_add_u32 s9, s8, 163840
  buffer_load_dwordx4 v[40:43], v2, s[44:47], s9 offen offset:1024 nt
  s_waitcnt vmcnt(6)
  v_lshlrev_b32 v211, 16, v196
  v_lshlrev_b32 v212, 16, v200
  v_lshlrev_b32 v213, 16, v204
  v_mul_f32 v223, s16, v211
  v_mul_f32 v224, s17, v211
  v_mul_f32 v225, s18, v211
  v_mul_f32 v226, s19, v211
  v_mul_f32 v227, s20, v211
  v_mul_f32 v228, s21, v211
  v_mul_f32 v229, s22, v211
  v_mul_f32 v230, s23, v211
  v_mul_f32 v231, s24, v211
  v_cvt_pk_bf16_f32 v223, v223, v224
  v_cvt_pk_bf16_f32 v225, v225, v226
  v_cvt_pk_bf16_f32 v227, v227, v228
  v_cvt_pk_bf16_f32 v229, v229, v230
  v_cvt_pk_bf16_f32 v231, v231, v231
  v_and_b32 v224, 0xffff0000, v223
  v_lshlrev_b32 v223, 16, v223
  v_and_b32 v226, 0xffff0000, v225
  v_lshlrev_b32 v225, 16, v225
  v_and_b32 v228, 0xffff0000, v227
  v_lshlrev_b32 v227, 16, v227
  v_and_b32 v230, 0xffff0000, v229
  v_lshlrev_b32 v229, 16, v229
  v_lshlrev_b32 v231, 16, v231
  v_add_f32 v223, v223, v212
  v_add_f32 v224, v224, v212
  v_add_f32 v225, v225, v212
  v_add_f32 v226, v226, v212
  v_add_f32 v227, v227, v212
  v_add_f32 v228, v228, v212
  v_add_f32 v229, v229, v212
  v_add_f32 v230, v230, v212
  v_add_f32 v231, v231, v212
  v_cvt_pk_bf16_f32 v223, v223, v224
  v_cvt_pk_bf16_f32 v225, v225, v226
  v_cvt_pk_bf16_f32 v227, v227, v228
  v_cvt_pk_bf16_f32 v229, v229, v230
  v_cvt_pk_bf16_f32 v231, v231, v231
  v_and_b32 v224, 0xffff0000, v223
  v_lshlrev_b32 v223, 16, v223
  v_and_b32 v226, 0xffff0000, v225
  v_lshlrev_b32 v225, 16, v225
  v_and_b32 v228, 0xffff0000, v227
  v_lshlrev_b32 v227, 16, v227
  v_and_b32 v230, 0xffff0000, v229
  v_lshlrev_b32 v229, 16, v229
  v_lshlrev_b32 v231, 16, v231
  v_mul_f32 v232, v223, v223
  v_mul_f32 v233, v224, v224
  v_mul_f32 v234, v225, v225
  v_mul_f32 v235, v226, v226
  v_mul_f32 v236, v227, v227
  v_mul_f32 v237, v228, v228
  v_mul_f32 v238, v229, v229
  v_mul_f32 v239, v230, v230
  v_mul_f32 v240, v231, v231
  v_fmaak_f32 v232, v13, v232, 0xc0135761
  v_fmaak_f32 v233, v13, v233, 0xc0135761
  v_fmaak_f32 v234, v13, v234, 0xc0135761
  v_fmaak_f32 v235, v13, v235, 0xc0135761
  v_fmaak_f32 v236, v13, v236, 0xc0135761
  v_fmaak_f32 v237, v13, v237, 0xc0135761
  v_fmaak_f32 v238, v13, v238, 0xc0135761
  v_fmaak_f32 v239, v13, v239, 0xc0135761
  v_fmaak_f32 v240, v13, v240, 0xc0135761
  v_mul_f32 v232, v232, v223
  v_mul_f32 v233, v233, v224
  v_mul_f32 v234, v234, v225
  v_mul_f32 v235, v235, v226
  v_mul_f32 v236, v236, v227
  v_mul_f32 v237, v237, v228
  v_mul_f32 v238, v238, v229
  v_mul_f32 v239, v239, v230
  v_mul_f32 v240, v240, v231
  v_exp_f32 v232, v232
  v_exp_f32 v233, v233
  v_exp_f32 v234, v234
  v_exp_f32 v235, v235
  v_exp_f32 v236, v236
  v_exp_f32 v237, v237
  v_exp_f32 v238, v238
  v_exp_f32 v239, v239
  v_exp_f32 v240, v240
  v_add_f32 v232, 1.0, v232
  v_add_f32 v233, 1.0, v233
  v_add_f32 v234, 1.0, v234
  v_add_f32 v235, 1.0, v235
  v_add_f32 v236, 1.0, v236
  v_add_f32 v237, 1.0, v237
  v_add_f32 v238, 1.0, v238
  v_add_f32 v239, 1.0, v239
  v_add_f32 v240, 1.0, v240
  v_rcp_f32 v232, v232
  v_rcp_f32 v233, v233
  v_rcp_f32 v234, v234
  v_rcp_f32 v235, v235
  v_rcp_f32 v236, v236
  v_rcp_f32 v237, v237
  v_rcp_f32 v238, v238
  v_rcp_f32 v239, v239
  v_rcp_f32 v240, v240
  v_mul_f32 v223, v223, v232
  v_mul_f32 v224, v224, v233
  v_mul_f32 v225, v225, v234
  v_mul_f32 v226, v226, v235
  v_mul_f32 v227, v227, v236
  v_mul_f32 v228, v228, v237
  v_mul_f32 v229, v229, v238
  v_mul_f32 v230, v230, v239
  v_mul_f32 v231, v231, v240
  v_cvt_pk_bf16_f32 v223, v223, v224
  v_cvt_pk_bf16_f32 v225, v225, v226
  v_cvt_pk_bf16_f32 v227, v227, v228
  v_cvt_pk_bf16_f32 v229, v229, v230
  v_cvt_pk_bf16_f32 v231, v231, v231
  v_and_b32 v224, 0xffff0000, v223
  v_lshlrev_b32 v223, 16, v223
  v_and_b32 v226, 0xffff0000, v225
  v_lshlrev_b32 v225, 16, v225
  v_and_b32 v228, 0xffff0000, v227
  v_lshlrev_b32 v227, 16, v227
  v_and_b32 v230, 0xffff0000, v229
  v_lshlrev_b32 v229, 16, v229
  v_lshlrev_b32 v231, 16, v231
  v_fmac_f32 v214, v223, v213
  v_fmac_f32 v215, v224, v213
  v_fmac_f32 v216, v225, v213
  v_fmac_f32 v217, v226, v213
  v_fmac_f32 v218, v227, v213
  v_fmac_f32 v219, v228, v213
  v_fmac_f32 v220, v229, v213
  v_fmac_f32 v221, v230, v213
  v_fmac_f32 v222, v231, v213
  s_add_u32 s9, s8, 163840
  buffer_load_dwordx4 v[44:47], v2, s[44:47], s9 offen offset:2048 nt
  s_add_u32 s9, s8, 163840
  buffer_load_dwordx4 v[48:51], v2, s[44:47], s9 offen offset:3072 nt
  s_barrier
  s_waitcnt vmcnt(7)
  s_add_u32 s9, s8, 196608
  buffer_load_dwordx4 v[52:55], v2, s[44:47], s9 offen offset:0 nt
  buffer_load_dword v248, v9, s[84:87], 0 offen sc0 sc1
  s_waitcnt vmcnt(8)
  s_add_u32 s9, s8, 196608
  buffer_load_dwordx4 v[56:59], v2, s[44:47], s9 offen offset:1024 nt
  v_and_b32 v211, 0xffff0000, v196
  v_and_b32 v212, 0xffff0000, v200
  v_and_b32 v213, 0xffff0000, v204
  v_mul_f32 v223, s16, v211
  v_mul_f32 v224, s17, v211
  v_mul_f32 v225, s18, v211
  v_mul_f32 v226, s19, v211
  v_mul_f32 v227, s20, v211
  v_mul_f32 v228, s21, v211
  v_mul_f32 v229, s22, v211
  v_mul_f32 v230, s23, v211
  v_mul_f32 v231, s24, v211
  v_cvt_pk_bf16_f32 v223, v223, v224
  v_cvt_pk_bf16_f32 v225, v225, v226
  v_cvt_pk_bf16_f32 v227, v227, v228
  v_cvt_pk_bf16_f32 v229, v229, v230
  v_cvt_pk_bf16_f32 v231, v231, v231
  v_and_b32 v224, 0xffff0000, v223
  v_lshlrev_b32 v223, 16, v223
  v_and_b32 v226, 0xffff0000, v225
  v_lshlrev_b32 v225, 16, v225
  v_and_b32 v228, 0xffff0000, v227
  v_lshlrev_b32 v227, 16, v227
  v_and_b32 v230, 0xffff0000, v229
  v_lshlrev_b32 v229, 16, v229
  v_lshlrev_b32 v231, 16, v231
  v_add_f32 v223, v223, v212
  v_add_f32 v224, v224, v212
  v_add_f32 v225, v225, v212
  v_add_f32 v226, v226, v212
  v_add_f32 v227, v227, v212
  v_add_f32 v228, v228, v212
  v_add_f32 v229, v229, v212
  v_add_f32 v230, v230, v212
  v_add_f32 v231, v231, v212
  v_cvt_pk_bf16_f32 v223, v223, v224
  v_cvt_pk_bf16_f32 v225, v225, v226
  v_cvt_pk_bf16_f32 v227, v227, v228
  v_cvt_pk_bf16_f32 v229, v229, v230
  v_cvt_pk_bf16_f32 v231, v231, v231
  v_and_b32 v224, 0xffff0000, v223
  v_lshlrev_b32 v223, 16, v223
  v_and_b32 v226, 0xffff0000, v225
  v_lshlrev_b32 v225, 16, v225
  v_and_b32 v228, 0xffff0000, v227
  v_lshlrev_b32 v227, 16, v227
  v_and_b32 v230, 0xffff0000, v229
  v_lshlrev_b32 v229, 16, v229
  v_lshlrev_b32 v231, 16, v231
  v_mul_f32 v232, v223, v223
  v_mul_f32 v233, v224, v224
  v_mul_f32 v234, v225, v225
  v_mul_f32 v235, v226, v226
  v_mul_f32 v236, v227, v227
  v_mul_f32 v237, v228, v228
  v_mul_f32 v238, v229, v229
  v_mul_f32 v239, v230, v230
  v_mul_f32 v240, v231, v231
  v_fmaak_f32 v232, v13, v232, 0xc0135761
  v_fmaak_f32 v233, v13, v233, 0xc0135761
  v_fmaak_f32 v234, v13, v234, 0xc0135761
  v_fmaak_f32 v235, v13, v235, 0xc0135761
  v_fmaak_f32 v236, v13, v236, 0xc0135761
  v_fmaak_f32 v237, v13, v237, 0xc0135761
  v_fmaak_f32 v238, v13, v238, 0xc0135761
  v_fmaak_f32 v239, v13, v239, 0xc0135761
  v_fmaak_f32 v240, v13, v240, 0xc0135761
  v_mul_f32 v232, v232, v223
  v_mul_f32 v233, v233, v224
  v_mul_f32 v234, v234, v225
  v_mul_f32 v235, v235, v226
  v_mul_f32 v236, v236, v227
  v_mul_f32 v237, v237, v228
  v_mul_f32 v238, v238, v229
  v_mul_f32 v239, v239, v230
  v_mul_f32 v240, v240, v231
  v_exp_f32 v232, v232
  v_exp_f32 v233, v233
  v_exp_f32 v234, v234
  v_exp_f32 v235, v235
  v_exp_f32 v236, v236
  v_exp_f32 v237, v237
  v_exp_f32 v238, v238
  v_exp_f32 v239, v239
  v_exp_f32 v240, v240
  v_add_f32 v232, 1.0, v232
  v_add_f32 v233, 1.0, v233
  v_add_f32 v234, 1.0, v234
  v_add_f32 v235, 1.0, v235
  v_add_f32 v236, 1.0, v236
  v_add_f32 v237, 1.0, v237
  v_add_f32 v238, 1.0, v238
  v_add_f32 v239, 1.0, v239
  v_add_f32 v240, 1.0, v240
  v_rcp_f32 v232, v232
  v_rcp_f32 v233, v233
  v_rcp_f32 v234, v234
  v_rcp_f32 v235, v235
  v_rcp_f32 v236, v236
  v_rcp_f32 v237, v237
  v_rcp_f32 v238, v238
  v_rcp_f32 v239, v239
  v_rcp_f32 v240, v240
  v_mul_f32 v223, v223, v232
  v_mul_f32 v224, v224, v233
  v_mul_f32 v225, v225, v234
  v_mul_f32 v226, v226, v235
  v_mul_f32 v227, v227, v236
  v_mul_f32 v228, v228, v237
  v_mul_f32 v229, v229, v238
  v_mul_f32 v230, v230, v239
  v_mul_f32 v231, v231, v240
  v_cvt_pk_bf16_f32 v223, v223, v224
  v_cvt_pk_bf16_f32 v225, v225, v226
  v_cvt_pk_bf16_f32 v227, v227, v228
  v_cvt_pk_bf16_f32 v229, v229, v230
  v_cvt_pk_bf16_f32 v231, v231, v231
  v_and_b32 v224, 0xffff0000, v223
  v_lshlrev_b32 v223, 16, v223
  v_and_b32 v226, 0xffff0000, v225
  v_lshlrev_b32 v225, 16, v225
  v_and_b32 v228, 0xffff0000, v227
  v_lshlrev_b32 v227, 16, v227
  v_and_b32 v230, 0xffff0000, v229
  v_lshlrev_b32 v229, 16, v229
  v_lshlrev_b32 v231, 16, v231
  v_fmac_f32 v214, v223, v213
  v_fmac_f32 v215, v224, v213
  v_fmac_f32 v216, v225, v213
  v_fmac_f32 v217, v226, v213
  v_fmac_f32 v218, v227, v213
  v_fmac_f32 v219, v228, v213
  v_fmac_f32 v220, v229, v213
  v_fmac_f32 v221, v230, v213
  v_fmac_f32 v222, v231, v213
  s_waitcnt vmcnt(8)
  s_add_u32 s9, s8, 196608
  buffer_load_dwordx4 v[60:63], v2, s[44:47], s9 offen offset:2048 nt
  s_waitcnt vmcnt(8)
  s_add_u32 s9, s8, 196608
  buffer_load_dwordx4 v[64:67], v2, s[44:47], s9 offen offset:3072 nt
  s_barrier
  s_waitcnt vmcnt(8)
  s_add_u32 s9, s8, 229376
  buffer_load_dwordx4 v[68:71], v2, s[44:47], s9 offen offset:0 nt
  s_waitcnt vmcnt(8)
  s_add_u32 s9, s8, 229376
  buffer_load_dwordx4 v[72:75], v2, s[44:47], s9 offen offset:1024 nt
  v_lshlrev_b32 v211, 16, v197
  v_lshlrev_b32 v212, 16, v201
  v_lshlrev_b32 v213, 16, v205
  v_mul_f32 v223, s16, v211
  v_mul_f32 v224, s17, v211
  v_mul_f32 v225, s18, v211
  v_mul_f32 v226, s19, v211
  v_mul_f32 v227, s20, v211
  v_mul_f32 v228, s21, v211
  v_mul_f32 v229, s22, v211
  v_mul_f32 v230, s23, v211
  v_mul_f32 v231, s24, v211
  v_cvt_pk_bf16_f32 v223, v223, v224
  v_cvt_pk_bf16_f32 v225, v225, v226
  v_cvt_pk_bf16_f32 v227, v227, v228
  v_cvt_pk_bf16_f32 v229, v229, v230
  v_cvt_pk_bf16_f32 v231, v231, v231
  v_and_b32 v224, 0xffff0000, v223
  v_lshlrev_b32 v223, 16, v223
  v_and_b32 v226, 0xffff0000, v225
  v_lshlrev_b32 v225, 16, v225
  v_and_b32 v228, 0xffff0000, v227
  v_lshlrev_b32 v227, 16, v227
  v_and_b32 v230, 0xffff0000, v229
  v_lshlrev_b32 v229, 16, v229
  v_lshlrev_b32 v231, 16, v231
  v_add_f32 v223, v223, v212
  v_add_f32 v224, v224, v212
  v_add_f32 v225, v225, v212
  v_add_f32 v226, v226, v212
  v_add_f32 v227, v227, v212
  v_add_f32 v228, v228, v212
  v_add_f32 v229, v229, v212
  v_add_f32 v230, v230, v212
  v_add_f32 v231, v231, v212
  v_cvt_pk_bf16_f32 v223, v223, v224
  v_cvt_pk_bf16_f32 v225, v225, v226
  v_cvt_pk_bf16_f32 v227, v227, v228
  v_cvt_pk_bf16_f32 v229, v229, v230
  v_cvt_pk_bf16_f32 v231, v231, v231
  v_and_b32 v224, 0xffff0000, v223
  v_lshlrev_b32 v223, 16, v223
  v_and_b32 v226, 0xffff0000, v225
  v_lshlrev_b32 v225, 16, v225
  v_and_b32 v228, 0xffff0000, v227
  v_lshlrev_b32 v227, 16, v227
  v_and_b32 v230, 0xffff0000, v229
  v_lshlrev_b32 v229, 16, v229
  v_lshlrev_b32 v231, 16, v231
  v_mul_f32 v232, v223, v223
  v_mul_f32 v233, v224, v224
  v_mul_f32 v234, v225, v225
  v_mul_f32 v235, v226, v226
  v_mul_f32 v236, v227, v227
  v_mul_f32 v237, v228, v228
  v_mul_f32 v238, v229, v229
  v_mul_f32 v239, v230, v230
  v_mul_f32 v240, v231, v231
  v_fmaak_f32 v232, v13, v232, 0xc0135761
  v_fmaak_f32 v233, v13, v233, 0xc0135761
  v_fmaak_f32 v234, v13, v234, 0xc0135761
  v_fmaak_f32 v235, v13, v235, 0xc0135761
  v_fmaak_f32 v236, v13, v236, 0xc0135761
  v_fmaak_f32 v237, v13, v237, 0xc0135761
  v_fmaak_f32 v238, v13, v238, 0xc0135761
  v_fmaak_f32 v239, v13, v239, 0xc0135761
  v_fmaak_f32 v240, v13, v240, 0xc0135761
  v_mul_f32 v232, v232, v223
  v_mul_f32 v233, v233, v224
  v_mul_f32 v234, v234, v225
  v_mul_f32 v235, v235, v226
  v_mul_f32 v236, v236, v227
  v_mul_f32 v237, v237, v228
  v_mul_f32 v238, v238, v229
  v_mul_f32 v239, v239, v230
  v_mul_f32 v240, v240, v231
  v_exp_f32 v232, v232
  v_exp_f32 v233, v233
  v_exp_f32 v234, v234
  v_exp_f32 v235, v235
  v_exp_f32 v236, v236
  v_exp_f32 v237, v237
  v_exp_f32 v238, v238
  v_exp_f32 v239, v239
  v_exp_f32 v240, v240
  v_add_f32 v232, 1.0, v232
  v_add_f32 v233, 1.0, v233
  v_add_f32 v234, 1.0, v234
  v_add_f32 v235, 1.0, v235
  v_add_f32 v236, 1.0, v236
  v_add_f32 v237, 1.0, v237
  v_add_f32 v238, 1.0, v238
  v_add_f32 v239, 1.0, v239
  v_add_f32 v240, 1.0, v240
  v_rcp_f32 v232, v232
  v_rcp_f32 v233, v233
  v_rcp_f32 v234, v234
  v_rcp_f32 v235, v235
  v_rcp_f32 v236, v236
  v_rcp_f32 v237, v237
  v_rcp_f32 v238, v238
  v_rcp_f32 v239, v239
  v_rcp_f32 v240, v240
  v_mul_f32 v223, v223, v232
  v_mul_f32 v224, v224, v233
  v_mul_f32 v225, v225, v234
  v_mul_f32 v226, v226, v235
  v_mul_f32 v227, v227, v236
  v_mul_f32 v228, v228, v237
  v_mul_f32 v229, v229, v238
  v_mul_f32 v230, v230, v239
  v_mul_f32 v231, v231, v240
  v_cvt_pk_bf16_f32 v223, v223, v224
  v_cvt_pk_bf16_f32 v225, v225, v226
  v_cvt_pk_bf16_f32 v227, v227, v228
  v_cvt_pk_bf16_f32 v229, v229, v230
  v_cvt_pk_bf16_f32 v231, v231, v231
  v_and_b32 v224, 0xffff0000, v223
  v_lshlrev_b32 v223, 16, v223
  v_and_b32 v226, 0xffff0000, v225
  v_lshlrev_b32 v225, 16, v225
  v_and_b32 v228, 0xffff0000, v227
  v_lshlrev_b32 v227, 16, v227
  v_and_b32 v230, 0xffff0000, v229
  v_lshlrev_b32 v229, 16, v229
  v_lshlrev_b32 v231, 16, v231
  v_fmac_f32 v214, v223, v213
  v_fmac_f32 v215, v224, v213
  v_fmac_f32 v216, v225, v213
  v_fmac_f32 v217, v226, v213
  v_fmac_f32 v218, v227, v213
  v_fmac_f32 v219, v228, v213
  v_fmac_f32 v220, v229, v213
  v_fmac_f32 v221, v230, v213
  v_fmac_f32 v222, v231, v213
  s_waitcnt vmcnt(8)
  s_add_u32 s9, s8, 229376
  buffer_load_dwordx4 v[76:79], v2, s[44:47], s9 offen offset:2048 nt
  s_waitcnt vmcnt(8)
  s_add_u32 s9, s8, 229376
  buffer_load_dwordx4 v[80:83], v2, s[44:47], s9 offen offset:3072 nt
  s_barrier
  s_waitcnt vmcnt(8)
  s_add_u32 s9, s8, 262144
  buffer_load_dwordx4 v[84:87], v2, s[44:47], s9 offen offset:0 nt
  s_waitcnt vmcnt(8)
  v_cmp_eq_u32 vcc, 0x01010101, v248
  s_nop 1
  s_and_b64 s[98:99], vcc, s[38:39]
  s_cmp_eq_u64 s[98:99], s[38:39]
  s_cselect_b32 s37, 1, 0
  buffer_load_dwordx4 v[244:247], v10, s[88:91], s40 offen sc0 sc1
  buffer_load_dword v248, v9, s[84:87], 0 offen sc0 sc1
  s_waitcnt vmcnt(9)
  s_add_u32 s9, s8, 262144
  buffer_load_dwordx4 v[88:91], v2, s[44:47], s9 offen offset:1024 nt
  v_and_b32 v211, 0xffff0000, v197
  v_and_b32 v212, 0xffff0000, v201
  v_and_b32 v213, 0xffff0000, v205
  v_mul_f32 v223, s16, v211
  v_mul_f32 v224, s17, v211
  v_mul_f32 v225, s18, v211
  v_mul_f32 v226, s19, v211
  v_mul_f32 v227, s20, v211
  v_mul_f32 v228, s21, v211
  v_mul_f32 v229, s22, v211
  v_mul_f32 v230, s23, v211
  v_mul_f32 v231, s24, v211
  v_cvt_pk_bf16_f32 v223, v223, v224
  v_cvt_pk_bf16_f32 v225, v225, v226
  v_cvt_pk_bf16_f32 v227, v227, v228
  v_cvt_pk_bf16_f32 v229, v229, v230
  v_cvt_pk_bf16_f32 v231, v231, v231
  v_and_b32 v224, 0xffff0000, v223
  v_lshlrev_b32 v223, 16, v223
  v_and_b32 v226, 0xffff0000, v225
  v_lshlrev_b32 v225, 16, v225
  v_and_b32 v228, 0xffff0000, v227
  v_lshlrev_b32 v227, 16, v227
  v_and_b32 v230, 0xffff0000, v229
  v_lshlrev_b32 v229, 16, v229
  v_lshlrev_b32 v231, 16, v231
  v_add_f32 v223, v223, v212
  v_add_f32 v224, v224, v212
  v_add_f32 v225, v225, v212
  v_add_f32 v226, v226, v212
  v_add_f32 v227, v227, v212
  v_add_f32 v228, v228, v212
  v_add_f32 v229, v229, v212
  v_add_f32 v230, v230, v212
  v_add_f32 v231, v231, v212
  v_cvt_pk_bf16_f32 v223, v223, v224
  v_cvt_pk_bf16_f32 v225, v225, v226
  v_cvt_pk_bf16_f32 v227, v227, v228
  v_cvt_pk_bf16_f32 v229, v229, v230
  v_cvt_pk_bf16_f32 v231, v231, v231
  v_and_b32 v224, 0xffff0000, v223
  v_lshlrev_b32 v223, 16, v223
  v_and_b32 v226, 0xffff0000, v225
  v_lshlrev_b32 v225, 16, v225
  v_and_b32 v228, 0xffff0000, v227
  v_lshlrev_b32 v227, 16, v227
  v_and_b32 v230, 0xffff0000, v229
  v_lshlrev_b32 v229, 16, v229
  v_lshlrev_b32 v231, 16, v231
  v_mul_f32 v232, v223, v223
  v_mul_f32 v233, v224, v224
  v_mul_f32 v234, v225, v225
  v_mul_f32 v235, v226, v226
  v_mul_f32 v236, v227, v227
  v_mul_f32 v237, v228, v228
  v_mul_f32 v238, v229, v229
  v_mul_f32 v239, v230, v230
  v_mul_f32 v240, v231, v231
  v_fmaak_f32 v232, v13, v232, 0xc0135761
  v_fmaak_f32 v233, v13, v233, 0xc0135761
  v_fmaak_f32 v234, v13, v234, 0xc0135761
  v_fmaak_f32 v235, v13, v235, 0xc0135761
  v_fmaak_f32 v236, v13, v236, 0xc0135761
  v_fmaak_f32 v237, v13, v237, 0xc0135761
  v_fmaak_f32 v238, v13, v238, 0xc0135761
  v_fmaak_f32 v239, v13, v239, 0xc0135761
  v_fmaak_f32 v240, v13, v240, 0xc0135761
  v_mul_f32 v232, v232, v223
  v_mul_f32 v233, v233, v224
  v_mul_f32 v234, v234, v225
  v_mul_f32 v235, v235, v226
  v_mul_f32 v236, v236, v227
  v_mul_f32 v237, v237, v228
  v_mul_f32 v238, v238, v229
  v_mul_f32 v239, v239, v230
  v_mul_f32 v240, v240, v231
  v_exp_f32 v232, v232
  v_exp_f32 v233, v233
  v_exp_f32 v234, v234
  v_exp_f32 v235, v235
  v_exp_f32 v236, v236
  v_exp_f32 v237, v237
  v_exp_f32 v238, v238
  v_exp_f32 v239, v239
  v_exp_f32 v240, v240
  v_add_f32 v232, 1.0, v232
  v_add_f32 v233, 1.0, v233
  v_add_f32 v234, 1.0, v234
  v_add_f32 v235, 1.0, v235
  v_add_f32 v236, 1.0, v236
  v_add_f32 v237, 1.0, v237
  v_add_f32 v238, 1.0, v238
  v_add_f32 v239, 1.0, v239
  v_add_f32 v240, 1.0, v240
  v_rcp_f32 v232, v232
  v_rcp_f32 v233, v233
  v_rcp_f32 v234, v234
  v_rcp_f32 v235, v235
  v_rcp_f32 v236, v236
  v_rcp_f32 v237, v237
  v_rcp_f32 v238, v238
  v_rcp_f32 v239, v239
  v_rcp_f32 v240, v240
  v_mul_f32 v223, v223, v232
  v_mul_f32 v224, v224, v233
  v_mul_f32 v225, v225, v234
  v_mul_f32 v226, v226, v235
  v_mul_f32 v227, v227, v236
  v_mul_f32 v228, v228, v237
  v_mul_f32 v229, v229, v238
  v_mul_f32 v230, v230, v239
  v_mul_f32 v231, v231, v240
  v_cvt_pk_bf16_f32 v223, v223, v224
  v_cvt_pk_bf16_f32 v225, v225, v226
  v_cvt_pk_bf16_f32 v227, v227, v228
  v_cvt_pk_bf16_f32 v229, v229, v230
  v_cvt_pk_bf16_f32 v231, v231, v231
  v_and_b32 v224, 0xffff0000, v223
  v_lshlrev_b32 v223, 16, v223
  v_and_b32 v226, 0xffff0000, v225
  v_lshlrev_b32 v225, 16, v225
  v_and_b32 v228, 0xffff0000, v227
  v_lshlrev_b32 v227, 16, v227
  v_and_b32 v230, 0xffff0000, v229
  v_lshlrev_b32 v229, 16, v229
  v_lshlrev_b32 v231, 16, v231
  v_fmac_f32 v214, v223, v213
  v_fmac_f32 v215, v224, v213
  v_fmac_f32 v216, v225, v213
  v_fmac_f32 v217, v226, v213
  v_fmac_f32 v218, v227, v213
  v_fmac_f32 v219, v228, v213
  v_fmac_f32 v220, v229, v213
  v_fmac_f32 v221, v230, v213
  v_fmac_f32 v222, v231, v213
  s_waitcnt vmcnt(9)
  s_add_u32 s9, s8, 262144
  buffer_load_dwordx4 v[92:95], v2, s[44:47], s9 offen offset:2048 nt
  s_waitcnt vmcnt(9)
  s_add_u32 s9, s8, 262144
  buffer_load_dwordx4 v[96:99], v2, s[44:47], s9 offen offset:3072 nt
  s_barrier
  s_waitcnt vmcnt(9)
  s_add_u32 s9, s8, 294912
  buffer_load_dwordx4 v[100:103], v2, s[44:47], s9 offen offset:0 nt
  s_waitcnt vmcnt(9)
  s_add_u32 s9, s8, 294912
  buffer_load_dwordx4 v[104:107], v2, s[44:47], s9 offen offset:1024 nt
  v_lshlrev_b32 v211, 16, v198
  v_lshlrev_b32 v212, 16, v202
  v_lshlrev_b32 v213, 16, v206
  v_mul_f32 v223, s16, v211
  v_mul_f32 v224, s17, v211
  v_mul_f32 v225, s18, v211
  v_mul_f32 v226, s19, v211
  v_mul_f32 v227, s20, v211
  v_mul_f32 v228, s21, v211
  v_mul_f32 v229, s22, v211
  v_mul_f32 v230, s23, v211
  v_mul_f32 v231, s24, v211
  v_cvt_pk_bf16_f32 v223, v223, v224
  v_cvt_pk_bf16_f32 v225, v225, v226
  v_cvt_pk_bf16_f32 v227, v227, v228
  v_cvt_pk_bf16_f32 v229, v229, v230
  v_cvt_pk_bf16_f32 v231, v231, v231
  v_and_b32 v224, 0xffff0000, v223
  v_lshlrev_b32 v223, 16, v223
  v_and_b32 v226, 0xffff0000, v225
  v_lshlrev_b32 v225, 16, v225
  v_and_b32 v228, 0xffff0000, v227
  v_lshlrev_b32 v227, 16, v227
  v_and_b32 v230, 0xffff0000, v229
  v_lshlrev_b32 v229, 16, v229
  v_lshlrev_b32 v231, 16, v231
  v_add_f32 v223, v223, v212
  v_add_f32 v224, v224, v212
  v_add_f32 v225, v225, v212
  v_add_f32 v226, v226, v212
  v_add_f32 v227, v227, v212
  v_add_f32 v228, v228, v212
  v_add_f32 v229, v229, v212
  v_add_f32 v230, v230, v212
  v_add_f32 v231, v231, v212
  v_cvt_pk_bf16_f32 v223, v223, v224
  v_cvt_pk_bf16_f32 v225, v225, v226
  v_cvt_pk_bf16_f32 v227, v227, v228
  v_cvt_pk_bf16_f32 v229, v229, v230
  v_cvt_pk_bf16_f32 v231, v231, v231
  v_and_b32 v224, 0xffff0000, v223
  v_lshlrev_b32 v223, 16, v223
  v_and_b32 v226, 0xffff0000, v225
  v_lshlrev_b32 v225, 16, v225
  v_and_b32 v228, 0xffff0000, v227
  v_lshlrev_b32 v227, 16, v227
  v_and_b32 v230, 0xffff0000, v229
  v_lshlrev_b32 v229, 16, v229
  v_lshlrev_b32 v231, 16, v231
  v_mul_f32 v232, v223, v223
  v_mul_f32 v233, v224, v224
  v_mul_f32 v234, v225, v225
  v_mul_f32 v235, v226, v226
  v_mul_f32 v236, v227, v227
  v_mul_f32 v237, v228, v228
  v_mul_f32 v238, v229, v229
  v_mul_f32 v239, v230, v230
  v_mul_f32 v240, v231, v231
  v_fmaak_f32 v232, v13, v232, 0xc0135761
  v_fmaak_f32 v233, v13, v233, 0xc0135761
  v_fmaak_f32 v234, v13, v234, 0xc0135761
  v_fmaak_f32 v235, v13, v235, 0xc0135761
  v_fmaak_f32 v236, v13, v236, 0xc0135761
  v_fmaak_f32 v237, v13, v237, 0xc0135761
  v_fmaak_f32 v238, v13, v238, 0xc0135761
  v_fmaak_f32 v239, v13, v239, 0xc0135761
  v_fmaak_f32 v240, v13, v240, 0xc0135761
  v_mul_f32 v232, v232, v223
  v_mul_f32 v233, v233, v224
  v_mul_f32 v234, v234, v225
  v_mul_f32 v235, v235, v226
  v_mul_f32 v236, v236, v227
  v_mul_f32 v237, v237, v228
  v_mul_f32 v238, v238, v229
  v_mul_f32 v239, v239, v230
  v_mul_f32 v240, v240, v231
  v_exp_f32 v232, v232
  v_exp_f32 v233, v233
  v_exp_f32 v234, v234
  v_exp_f32 v235, v235
  v_exp_f32 v236, v236
  v_exp_f32 v237, v237
  v_exp_f32 v238, v238
  v_exp_f32 v239, v239
  v_exp_f32 v240, v240
  v_add_f32 v232, 1.0, v232
  v_add_f32 v233, 1.0, v233
  v_add_f32 v234, 1.0, v234
  v_add_f32 v235, 1.0, v235
  v_add_f32 v236, 1.0, v236
  v_add_f32 v237, 1.0, v237
  v_add_f32 v238, 1.0, v238
  v_add_f32 v239, 1.0, v239
  v_add_f32 v240, 1.0, v240
  v_rcp_f32 v232, v232
  v_rcp_f32 v233, v233
  v_rcp_f32 v234, v234
  v_rcp_f32 v235, v235
  v_rcp_f32 v236, v236
  v_rcp_f32 v237, v237
  v_rcp_f32 v238, v238
  v_rcp_f32 v239, v239
  v_rcp_f32 v240, v240
  v_mul_f32 v223, v223, v232
  v_mul_f32 v224, v224, v233
  v_mul_f32 v225, v225, v234
  v_mul_f32 v226, v226, v235
  v_mul_f32 v227, v227, v236
  v_mul_f32 v228, v228, v237
  v_mul_f32 v229, v229, v238
  v_mul_f32 v230, v230, v239
  v_mul_f32 v231, v231, v240
  v_cvt_pk_bf16_f32 v223, v223, v224
  v_cvt_pk_bf16_f32 v225, v225, v226
  v_cvt_pk_bf16_f32 v227, v227, v228
  v_cvt_pk_bf16_f32 v229, v229, v230
  v_cvt_pk_bf16_f32 v231, v231, v231
  v_and_b32 v224, 0xffff0000, v223
  v_lshlrev_b32 v223, 16, v223
  v_and_b32 v226, 0xffff0000, v225
  v_lshlrev_b32 v225, 16, v225
  v_and_b32 v228, 0xffff0000, v227
  v_lshlrev_b32 v227, 16, v227
  v_and_b32 v230, 0xffff0000, v229
  v_lshlrev_b32 v229, 16, v229
  v_lshlrev_b32 v231, 16, v231
  v_fmac_f32 v214, v223, v213
  v_fmac_f32 v215, v224, v213
  v_fmac_f32 v216, v225, v213
  v_fmac_f32 v217, v226, v213
  v_fmac_f32 v218, v227, v213
  v_fmac_f32 v219, v228, v213
  v_fmac_f32 v220, v229, v213
  v_fmac_f32 v221, v230, v213
  v_fmac_f32 v222, v231, v213
  s_waitcnt vmcnt(9)
  s_add_u32 s9, s8, 294912
  buffer_load_dwordx4 v[108:111], v2, s[44:47], s9 offen offset:2048 nt
  s_waitcnt vmcnt(9)
  s_add_u32 s9, s8, 297984
  s_add_u32 s94, s42, 0
  s_mov_b32 m0, s94
  s_nop 0
  buffer_load_dwordx4 v2, s[44:47], s9 offen nt lds
  s_barrier
  s_waitcnt vmcnt(9)
  s_add_u32 s9, s8, 327680
  s_add_u32 s94, s42, 1024
  s_mov_b32 m0, s94
  s_nop 0
  buffer_load_dwordx4 v2, s[44:47], s9 offen nt lds
  s_waitcnt vmcnt(8)
  s_cmp_eq_u32 s36, 1
  s_cbranch_scc1 L_att_1
  s_cmp_eq_u32 s37, 0
  s_cbranch_scc1 L_att_1
  v_max_u32 v249, v244, v245
  v_max3_u32 v249, v249, v246, v247
  v_cmp_eq_u32 vcc, -1, v249
  s_nop 1
  s_cmp_eq_u64 vcc, 0
  s_cbranch_scc0 L_att_1
  s_lshl_b32 s9, s3, 10
  s_add_u32 s9, s9, 96256
  v_lshl_add_u32 v4, v1, 4, s9
  ds_write_b128 v4, v[244:247]
  v_mov_b32 v4, 104448
  v_mov_b32 v5, 1
  s_waitcnt lgkmcnt(0)
  s_mov_b64 exec, 1
  ds_add_u32 v4, v5 offset:4
  s_mov_b64 exec, -1
  s_mov_b32 s36, 1
L_att_1:
  s_nop 7
  v_cmp_eq_u32 vcc, 0x01010101, v248
  s_nop 1
  s_and_b64 s[98:99], vcc, s[38:39]
  s_cmp_eq_u64 s[98:99], s[38:39]
  s_cselect_b32 s37, 1, 0
  buffer_load_dwordx4 v[244:247], v10, s[88:91], s40 offen sc0 sc1
  buffer_load_dword v248, v9, s[84:87], 0 offen sc0 sc1
  s_waitcnt vmcnt(9)
  s_add_u32 s9, s8, 328704
  s_add_u32 s94, s42, 2048
  s_mov_b32 m0, s94
  s_nop 0
  buffer_load_dwordx4 v2, s[44:47], s9 offen nt lds
  v_and_b32 v211, 0xffff0000, v198
  v_and_b32 v212, 0xffff0000, v202
  v_and_b32 v213, 0xffff0000, v206
  v_mul_f32 v223, s16, v211
  v_mul_f32 v224, s17, v211
  v_mul_f32 v225, s18, v211
  v_mul_f32 v226, s19, v211
  v_mul_f32 v227, s20, v211
  v_mul_f32 v228, s21, v211
  v_mul_f32 v229, s22, v211
  v_mul_f32 v230, s23, v211
  v_mul_f32 v231, s24, v211
  v_cvt_pk_bf16_f32 v223, v223, v224
  v_cvt_pk_bf16_f32 v225, v225, v226
  v_cvt_pk_bf16_f32 v227, v227, v228
  v_cvt_pk_bf16_f32 v229, v229, v230
  v_cvt_pk_bf16_f32 v231, v231, v231
  v_and_b32 v224, 0xffff0000, v223
  v_lshlrev_b32 v223, 16, v223
  v_and_b32 v226, 0xffff0000, v225
  v_lshlrev_b32 v225, 16, v225
  v_and_b32 v228, 0xffff0000, v227
  v_lshlrev_b32 v227, 16, v227
  v_and_b32 v230, 0xffff0000, v229
  v_lshlrev_b32 v229, 16, v229
  v_lshlrev_b32 v231, 16, v231
  v_add_f32 v223, v223, v212
  v_add_f32 v224, v224, v212
  v_add_f32 v225, v225, v212
  v_add_f32 v226, v226, v212
  v_add_f32 v227, v227, v212
  v_add_f32 v228, v228, v212
  v_add_f32 v229, v229, v212
  v_add_f32 v230, v230, v212
  v_add_f32 v231, v231, v212
  v_cvt_pk_bf16_f32 v223, v223, v224
  v_cvt_pk_bf16_f32 v225, v225, v226
  v_cvt_pk_bf16_f32 v227, v227, v228
  v_cvt_pk_bf16_f32 v229, v229, v230
  v_cvt_pk_bf16_f32 v231, v231, v231
  v_and_b32 v224, 0xffff0000, v223
  v_lshlrev_b32 v223, 16, v223
  v_and_b32 v226, 0xffff0000, v225
  v_lshlrev_b32 v225, 16, v225
  v_and_b32 v228, 0xffff0000, v227
  v_lshlrev_b32 v227, 16, v227
  v_and_b32 v230, 0xffff0000, v229
  v_lshlrev_b32 v229, 16, v229
  v_lshlrev_b32 v231, 16, v231
  v_mul_f32 v232, v223, v223
  v_mul_f32 v233, v224, v224
  v_mul_f32 v234, v225, v225
  v_mul_f32 v235, v226, v226
  v_mul_f32 v236, v227, v227
  v_mul_f32 v237, v228, v228
  v_mul_f32 v238, v229, v229
  v_mul_f32 v239, v230, v230
  v_mul_f32 v240, v231, v231
  v_fmaak_f32 v232, v13, v232, 0xc0135761
  v_fmaak_f32 v233, v13, v233, 0xc0135761
  v_fmaak_f32 v234, v13, v234, 0xc0135761
  v_fmaak_f32 v235, v13, v235, 0xc0135761
  v_fmaak_f32 v236, v13, v236, 0xc0135761
  v_fmaak_f32 v237, v13, v237, 0xc0135761
  v_fmaak_f32 v238, v13, v238, 0xc0135761
  v_fmaak_f32 v239, v13, v239, 0xc0135761
  v_fmaak_f32 v240, v13, v240, 0xc0135761
  v_mul_f32 v232, v232, v223
  v_mul_f32 v233, v233, v224
  v_mul_f32 v234, v234, v225
  v_mul_f32 v235, v235, v226
  v_mul_f32 v236, v236, v227
  v_mul_f32 v237, v237, v228
  v_mul_f32 v238, v238, v229
  v_mul_f32 v239, v239, v230
  v_mul_f32 v240, v240, v231
  v_exp_f32 v232, v232
  v_exp_f32 v233, v233
  v_exp_f32 v234, v234
  v_exp_f32 v235, v235
  v_exp_f32 v236, v236
  v_exp_f32 v237, v237
  v_exp_f32 v238, v238
  v_exp_f32 v239, v239
  v_exp_f32 v240, v240
  v_add_f32 v232, 1.0, v232
  v_add_f32 v233, 1.0, v233
  v_add_f32 v234, 1.0, v234
  v_add_f32 v235, 1.0, v235
  v_add_f32 v236, 1.0, v236
  v_add_f32 v237, 1.0, v237
  v_add_f32 v238, 1.0, v238
  v_add_f32 v239, 1.0, v239
  v_add_f32 v240, 1.0, v240
  v_rcp_f32 v232, v232
  v_rcp_f32 v233, v233
  v_rcp_f32 v234, v234
  v_rcp_f32 v235, v235
  v_rcp_f32 v236, v236
  v_rcp_f32 v237, v237
  v_rcp_f32 v238, v238
  v_rcp_f32 v239, v239
  v_rcp_f32 v240, v240
  v_mul_f32 v223, v223, v232
  v_mul_f32 v224, v224, v233
  v_mul_f32 v225, v225, v234
  v_mul_f32 v226, v226, v235
  v_mul_f32 v227, v227, v236
  v_mul_f32 v228, v228, v237
  v_mul_f32 v229, v229, v238
  v_mul_f32 v230, v230, v239
  v_mul_f32 v231, v231, v240
  v_cvt_pk_bf16_f32 v223, v223, v224
  v_cvt_pk_bf16_f32 v225, v225, v226
  v_cvt_pk_bf16_f32 v227, v227, v228
  v_cvt_pk_bf16_f32 v229, v229, v230
  v_cvt_pk_bf16_f32 v231, v231, v231
  v_and_b32 v224, 0xffff0000, v223
  v_lshlrev_b32 v223, 16, v223
  v_and_b32 v226, 0xffff0000, v225
  v_lshlrev_b32 v225, 16, v225
  v_and_b32 v228, 0xffff0000, v227
  v_lshlrev_b32 v227, 16, v227
  v_and_b32 v230, 0xffff0000, v229
  v_lshlrev_b32 v229, 16, v229
  v_lshlrev_b32 v231, 16, v231
  v_fmac_f32 v214, v223, v213
  v_fmac_f32 v215, v224, v213
  v_fmac_f32 v216, v225, v213
  v_fmac_f32 v217, v226, v213
  v_fmac_f32 v218, v227, v213
  v_fmac_f32 v219, v228, v213
  v_fmac_f32 v220, v229, v213
  v_fmac_f32 v221, v230, v213
  v_fmac_f32 v222, v231, v213
  s_waitcnt vmcnt(9)
  s_add_u32 s9, s8, 329728
  s_add_u32 s94, s42, 3072
  s_mov_b32 m0, s94
  s_nop 0
  buffer_load_dwordx4 v2, s[44:47], s9 offen nt lds
  s_waitcnt vmcnt(9)
  s_add_u32 s9, s8, 330752
  s_add_u32 s94, s42, 4096
  s_mov_b32 m0, s94
  s_nop 0
  buffer_load_dwordx4 v2, s[44:47], s9 offen nt lds
  s_barrier
  s_waitcnt vmcnt(9)
  s_add_u32 s9, s8, 360448
  s_add_u32 s94, s42, 5120
  s_mov_b32 m0, s94
  s_nop 0
  buffer_load_dwordx4 v2, s[44:47], s9 offen nt lds
  s_waitcnt vmcnt(9)
  s_add_u32 s9, s8, 361472
  s_add_u32 s94, s42, 6144
  s_mov_b32 m0, s94
  s_nop 0
  buffer_load_dwordx4 v2, s[44:47], s9 offen nt lds
  v_lshlrev_b32 v211, 16, v199
  v_lshlrev_b32 v212, 16, v203
  v_lshlrev_b32 v213, 16, v207
  v_mul_f32 v223, s16, v211
  v_mul_f32 v224, s17, v211
  v_mul_f32 v225, s18, v211
  v_mul_f32 v226, s19, v211
  v_mul_f32 v227, s20, v211
  v_mul_f32 v228, s21, v211
  v_mul_f32 v229, s22, v211
  v_mul_f32 v230, s23, v211
  v_mul_f32 v231, s24, v211
  v_cvt_pk_bf16_f32 v223, v223, v224
  v_cvt_pk_bf16_f32 v225, v225, v226
  v_cvt_pk_bf16_f32 v227, v227, v228
  v_cvt_pk_bf16_f32 v229, v229, v230
  v_cvt_pk_bf16_f32 v231, v231, v231
  v_and_b32 v224, 0xffff0000, v223
  v_lshlrev_b32 v223, 16, v223
  v_and_b32 v226, 0xffff0000, v225
  v_lshlrev_b32 v225, 16, v225
  v_and_b32 v228, 0xffff0000, v227
  v_lshlrev_b32 v227, 16, v227
  v_and_b32 v230, 0xffff0000, v229
  v_lshlrev_b32 v229, 16, v229
  v_lshlrev_b32 v231, 16, v231
  v_add_f32 v223, v223, v212
  v_add_f32 v224, v224, v212
  v_add_f32 v225, v225, v212
  v_add_f32 v226, v226, v212
  v_add_f32 v227, v227, v212
  v_add_f32 v228, v228, v212
  v_add_f32 v229, v229, v212
  v_add_f32 v230, v230, v212
  v_add_f32 v231, v231, v212
  v_cvt_pk_bf16_f32 v223, v223, v224
  v_cvt_pk_bf16_f32 v225, v225, v226
  v_cvt_pk_bf16_f32 v227, v227, v228
  v_cvt_pk_bf16_f32 v229, v229, v230
  v_cvt_pk_bf16_f32 v231, v231, v231
  v_and_b32 v224, 0xffff0000, v223
  v_lshlrev_b32 v223, 16, v223
  v_and_b32 v226, 0xffff0000, v225
  v_lshlrev_b32 v225, 16, v225
  v_and_b32 v228, 0xffff0000, v227
  v_lshlrev_b32 v227, 16, v227
  v_and_b32 v230, 0xffff0000, v229
  v_lshlrev_b32 v229, 16, v229
  v_lshlrev_b32 v231, 16, v231
  v_mul_f32 v232, v223, v223
  v_mul_f32 v233, v224, v224
  v_mul_f32 v234, v225, v225
  v_mul_f32 v235, v226, v226
  v_mul_f32 v236, v227, v227
  v_mul_f32 v237, v228, v228
  v_mul_f32 v238, v229, v229
  v_mul_f32 v239, v230, v230
  v_mul_f32 v240, v231, v231
  v_fmaak_f32 v232, v13, v232, 0xc0135761
  v_fmaak_f32 v233, v13, v233, 0xc0135761
  v_fmaak_f32 v234, v13, v234, 0xc0135761
  v_fmaak_f32 v235, v13, v235, 0xc0135761
  v_fmaak_f32 v236, v13, v236, 0xc0135761
  v_fmaak_f32 v237, v13, v237, 0xc0135761
  v_fmaak_f32 v238, v13, v238, 0xc0135761
  v_fmaak_f32 v239, v13, v239, 0xc0135761
  v_fmaak_f32 v240, v13, v240, 0xc0135761
  v_mul_f32 v232, v232, v223
  v_mul_f32 v233, v233, v224
  v_mul_f32 v234, v234, v225
  v_mul_f32 v235, v235, v226
  v_mul_f32 v236, v236, v227
  v_mul_f32 v237, v237, v228
  v_mul_f32 v238, v238, v229
  v_mul_f32 v239, v239, v230
  v_mul_f32 v240, v240, v231
  v_exp_f32 v232, v232
  v_exp_f32 v233, v233
  v_exp_f32 v234, v234
  v_exp_f32 v235, v235
  v_exp_f32 v236, v236
  v_exp_f32 v237, v237
  v_exp_f32 v238, v238
  v_exp_f32 v239, v239
  v_exp_f32 v240, v240
  v_add_f32 v232, 1.0, v232
  v_add_f32 v233, 1.0, v233
  v_add_f32 v234, 1.0, v234
  v_add_f32 v235, 1.0, v235
  v_add_f32 v236, 1.0, v236
  v_add_f32 v237, 1.0, v237
  v_add_f32 v238, 1.0, v238
  v_add_f32 v239, 1.0, v239
  v_add_f32 v240, 1.0, v240
  v_rcp_f32 v232, v232
  v_rcp_f32 v233, v233
  v_rcp_f32 v234, v234
  v_rcp_f32 v235, v235
  v_rcp_f32 v236, v236
  v_rcp_f32 v237, v237
  v_rcp_f32 v238, v238
  v_rcp_f32 v239, v239
  v_rcp_f32 v240, v240
  v_mul_f32 v223, v223, v232
  v_mul_f32 v224, v224, v233
  v_mul_f32 v225, v225, v234
  v_mul_f32 v226, v226, v235
  v_mul_f32 v227, v227, v236
  v_mul_f32 v228, v228, v237
  v_mul_f32 v229, v229, v238
  v_mul_f32 v230, v230, v239
  v_mul_f32 v231, v231, v240
  v_cvt_pk_bf16_f32 v223, v223, v224
  v_cvt_pk_bf16_f32 v225, v225, v226
  v_cvt_pk_bf16_f32 v227, v227, v228
  v_cvt_pk_bf16_f32 v229, v229, v230
  v_cvt_pk_bf16_f32 v231, v231, v231
  v_and_b32 v224, 0xffff0000, v223
  v_lshlrev_b32 v223, 16, v223
  v_and_b32 v226, 0xffff0000, v225
  v_lshlrev_b32 v225, 16, v225
  v_and_b32 v228, 0xffff0000, v227
  v_lshlrev_b32 v227, 16, v227
  v_and_b32 v230, 0xffff0000, v229
  v_lshlrev_b32 v229, 16, v229
  v_lshlrev_b32 v231, 16, v231
  v_fmac_f32 v214, v223, v213
  v_fmac_f32 v215, v224, v213
  v_fmac_f32 v216, v225, v213
  v_fmac_f32 v217, v226, v213
  v_fmac_f32 v218, v227, v213
  v_fmac_f32 v219, v228, v213
  v_fmac_f32 v220, v229, v213
  v_fmac_f32 v221, v230, v213
  v_fmac_f32 v222, v231, v213
  s_waitcnt vmcnt(9)
  s_add_u32 s9, s8, 362496
  s_add_u32 s94, s42, 7168
  s_mov_b32 m0, s94
  s_nop 0
  buffer_load_dwordx4 v2, s[44:47], s9 offen nt lds
  s_waitcnt vmcnt(9)
  s_add_u32 s9, s8, 363520
  s_add_u32 s94, s42, 8192
  s_mov_b32 m0, s94
  s_nop 0
  buffer_load_dwordx4 v2, s[44:47], s9 offen nt lds
  s_barrier
  s_waitcnt vmcnt(9)
  s_add_u32 s9, s8, 393216
  s_add_u32 s94, s41, 106496
  s_mov_b32 m0, s94
  s_nop 0
  buffer_load_dwordx4 v2, s[44:47], s9 offen nt lds
  s_waitcnt vmcnt(8)
  s_cmp_eq_u32 s36, 1
  s_cbranch_scc1 L_att_2
  s_cmp_eq_u32 s37, 0
  s_cbranch_scc1 L_att_2
  v_max_u32 v249, v244, v245
  v_max3_u32 v249, v249, v246, v247
  v_cmp_eq_u32 vcc, -1, v249
  s_nop 1
  s_cmp_eq_u64 vcc, 0
  s_cbranch_scc0 L_att_2
  s_lshl_b32 s9, s3, 10
  s_add_u32 s9, s9, 96256
  v_lshl_add_u32 v4, v1, 4, s9
  ds_write_b128 v4, v[244:247]
  v_mov_b32 v4, 104448
  v_mov_b32 v5, 1
  s_waitcnt lgkmcnt(0)
  s_mov_b64 exec, 1
  ds_add_u32 v4, v5 offset:4
  s_mov_b64 exec, -1
  s_mov_b32 s36, 1
L_att_2:
  s_nop 7
  v_cmp_eq_u32 vcc, 0x01010101, v248
  s_nop 1
  s_and_b64 s[98:99], vcc, s[38:39]
  s_cmp_eq_u64 s[98:99], s[38:39]
  s_cselect_b32 s37, 1, 0
  buffer_load_dwordx4 v[244:247], v10, s[88:91], s40 offen sc0 sc1
  buffer_load_dword v248, v9, s[84:87], 0 offen sc0 sc1
  s_waitcnt vmcnt(9)
  s_add_u32 s9, s8, 394240
  s_add_u32 s94, s41, 107520
  s_mov_b32 m0, s94
  s_nop 0
  buffer_load_dwordx4 v2, s[44:47], s9 offen nt lds
  v_and_b32 v211, 0xffff0000, v199
  v_and_b32 v212, 0xffff0000, v203
  v_and_b32 v213, 0xffff0000, v207
  v_mul_f32 v223, s16, v211
  v_mul_f32 v224, s17, v211
  v_mul_f32 v225, s18, v211
  v_mul_f32 v226, s19, v211
  v_mul_f32 v227, s20, v211
  v_mul_f32 v228, s21, v211
  v_mul_f32 v229, s22, v211
  v_mul_f32 v230, s23, v211
  v_mul_f32 v231, s24, v211
  v_cvt_pk_bf16_f32 v223, v223, v224
  v_cvt_pk_bf16_f32 v225, v225, v226
  v_cvt_pk_bf16_f32 v227, v227, v228
  v_cvt_pk_bf16_f32 v229, v229, v230
  v_cvt_pk_bf16_f32 v231, v231, v231
  v_and_b32 v224, 0xffff0000, v223
  v_lshlrev_b32 v223, 16, v223
  v_and_b32 v226, 0xffff0000, v225
  v_lshlrev_b32 v225, 16, v225
  v_and_b32 v228, 0xffff0000, v227
  v_lshlrev_b32 v227, 16, v227
  v_and_b32 v230, 0xffff0000, v229
  v_lshlrev_b32 v229, 16, v229
  v_lshlrev_b32 v231, 16, v231
  v_add_f32 v223, v223, v212
  v_add_f32 v224, v224, v212
  v_add_f32 v225, v225, v212
  v_add_f32 v226, v226, v212
  v_add_f32 v227, v227, v212
  v_add_f32 v228, v228, v212
  v_add_f32 v229, v229, v212
  v_add_f32 v230, v230, v212
  v_add_f32 v231, v231, v212
  v_cvt_pk_bf16_f32 v223, v223, v224
  v_cvt_pk_bf16_f32 v225, v225, v226
  v_cvt_pk_bf16_f32 v227, v227, v228
  v_cvt_pk_bf16_f32 v229, v229, v230
  v_cvt_pk_bf16_f32 v231, v231, v231
  v_and_b32 v224, 0xffff0000, v223
  v_lshlrev_b32 v223, 16, v223
  v_and_b32 v226, 0xffff0000, v225
  v_lshlrev_b32 v225, 16, v225
  v_and_b32 v228, 0xffff0000, v227
  v_lshlrev_b32 v227, 16, v227
  v_and_b32 v230, 0xffff0000, v229
  v_lshlrev_b32 v229, 16, v229
  v_lshlrev_b32 v231, 16, v231
  v_mul_f32 v232, v223, v223
  v_mul_f32 v233, v224, v224
  v_mul_f32 v234, v225, v225
  v_mul_f32 v235, v226, v226
  v_mul_f32 v236, v227, v227
  v_mul_f32 v237, v228, v228
  v_mul_f32 v238, v229, v229
  v_mul_f32 v239, v230, v230
  v_mul_f32 v240, v231, v231
  v_fmaak_f32 v232, v13, v232, 0xc0135761
  v_fmaak_f32 v233, v13, v233, 0xc0135761
  v_fmaak_f32 v234, v13, v234, 0xc0135761
  v_fmaak_f32 v235, v13, v235, 0xc0135761
  v_fmaak_f32 v236, v13, v236, 0xc0135761
  v_fmaak_f32 v237, v13, v237, 0xc0135761
  v_fmaak_f32 v238, v13, v238, 0xc0135761
  v_fmaak_f32 v239, v13, v239, 0xc0135761
  v_fmaak_f32 v240, v13, v240, 0xc0135761
  v_mul_f32 v232, v232, v223
  v_mul_f32 v233, v233, v224
  v_mul_f32 v234, v234, v225
  v_mul_f32 v235, v235, v226
  v_mul_f32 v236, v236, v227
  v_mul_f32 v237, v237, v228
  v_mul_f32 v238, v238, v229
  v_mul_f32 v239, v239, v230
  v_mul_f32 v240, v240, v231
  v_exp_f32 v232, v232
  v_exp_f32 v233, v233
  v_exp_f32 v234, v234
  v_exp_f32 v235, v235
  v_exp_f32 v236, v236
  v_exp_f32 v237, v237
  v_exp_f32 v238, v238
  v_exp_f32 v239, v239
  v_exp_f32 v240, v240
  v_add_f32 v232, 1.0, v232
  v_add_f32 v233, 1.0, v233
  v_add_f32 v234, 1.0, v234
  v_add_f32 v235, 1.0, v235
  v_add_f32 v236, 1.0, v236
  v_add_f32 v237, 1.0, v237
  v_add_f32 v238, 1.0, v238
  v_add_f32 v239, 1.0, v239
  v_add_f32 v240, 1.0, v240
  v_rcp_f32 v232, v232
  v_rcp_f32 v233, v233
  v_rcp_f32 v234, v234
  v_rcp_f32 v235, v235
  v_rcp_f32 v236, v236
  v_rcp_f32 v237, v237
  v_rcp_f32 v238, v238
  v_rcp_f32 v239, v239
  v_rcp_f32 v240, v240
  v_mul_f32 v223, v223, v232
  v_mul_f32 v224, v224, v233
  v_mul_f32 v225, v225, v234
  v_mul_f32 v226, v226, v235
  v_mul_f32 v227, v227, v236
  v_mul_f32 v228, v228, v237
  v_mul_f32 v229, v229, v238
  v_mul_f32 v230, v230, v239
  v_mul_f32 v231, v231, v240
  v_cvt_pk_bf16_f32 v223, v223, v224
  v_cvt_pk_bf16_f32 v225, v225, v226
  v_cvt_pk_bf16_f32 v227, v227, v228
  v_cvt_pk_bf16_f32 v229, v229, v230
  v_cvt_pk_bf16_f32 v231, v231, v231
  v_and_b32 v224, 0xffff0000, v223
  v_lshlrev_b32 v223, 16, v223
  v_and_b32 v226, 0xffff0000, v225
  v_lshlrev_b32 v225, 16, v225
  v_and_b32 v228, 0xffff0000, v227
  v_lshlrev_b32 v227, 16, v227
  v_and_b32 v230, 0xffff0000, v229
  v_lshlrev_b32 v229, 16, v229
  v_lshlrev_b32 v231, 16, v231
  v_fmac_f32 v214, v223, v213
  v_fmac_f32 v215, v224, v213
  v_fmac_f32 v216, v225, v213
  v_fmac_f32 v217, v226, v213
  v_fmac_f32 v218, v227, v213
  v_fmac_f32 v219, v228, v213
  v_fmac_f32 v220, v229, v213
  v_fmac_f32 v221, v230, v213
  v_fmac_f32 v222, v231, v213
  s_waitcnt vmcnt(9)
  s_add_u32 s9, s8, 395264
  s_add_u32 s94, s41, 108544
  s_mov_b32 m0, s94
  s_nop 0
  buffer_load_dwordx4 v2, s[44:47], s9 offen nt lds
  s_waitcnt vmcnt(9)
  s_add_u32 s9, s8, 396288
  s_add_u32 s94, s41, 109568
  s_mov_b32 m0, s94
  s_nop 0
  buffer_load_dwordx4 v2, s[44:47], s9 offen nt lds
  s_barrier
  s_waitcnt vmcnt(9)
  s_add_u32 s9, s8, 425984
  s_add_u32 s94, s41, 110592
  s_mov_b32 m0, s94
  s_nop 0
  buffer_load_dwordx4 v2, s[44:47], s9 offen nt lds
  s_waitcnt vmcnt(9)
  s_add_u32 s9, s8, 427008
  s_add_u32 s94, s41, 111616
  s_mov_b32 m0, s94
  s_nop 0
  buffer_load_dwordx4 v2, s[44:47], s9 offen nt lds
  v_lshlrev_b32 v211, 16, v208
  v_lshlrev_b32 v212, 16, v209
  v_lshlrev_b32 v213, 16, v210
  v_mul_f32 v223, s16, v211
  v_mul_f32 v224, s17, v211
  v_mul_f32 v225, s18, v211
  v_mul_f32 v226, s19, v211
  v_mul_f32 v227, s20, v211
  v_mul_f32 v228, s21, v211
  v_mul_f32 v229, s22, v211
  v_mul_f32 v230, s23, v211
  v_mul_f32 v231, s24, v211
  v_cvt_pk_bf16_f32 v223, v223, v224
  v_cvt_pk_bf16_f32 v225, v225, v226
  v_cvt_pk_bf16_f32 v227, v227, v228
  v_cvt_pk_bf16_f32 v229, v229, v230
  v_cvt_pk_bf16_f32 v231, v231, v231
  v_and_b32 v224, 0xffff0000, v223
  v_lshlrev_b32 v223, 16, v223
  v_and_b32 v226, 0xffff0000, v225
  v_lshlrev_b32 v225, 16, v225
  v_and_b32 v228, 0xffff0000, v227
  v_lshlrev_b32 v227, 16, v227
  v_and_b32 v230, 0xffff0000, v229
  v_lshlrev_b32 v229, 16, v229
  v_lshlrev_b32 v231, 16, v231
  v_add_f32 v223, v223, v212
  v_add_f32 v224, v224, v212
  v_add_f32 v225, v225, v212
  v_add_f32 v226, v226, v212
  v_add_f32 v227, v227, v212
  v_add_f32 v228, v228, v212
  v_add_f32 v229, v229, v212
  v_add_f32 v230, v230, v212
  v_add_f32 v231, v231, v212
  v_cvt_pk_bf16_f32 v223, v223, v224
  v_cvt_pk_bf16_f32 v225, v225, v226
  v_cvt_pk_bf16_f32 v227, v227, v228
  v_cvt_pk_bf16_f32 v229, v229, v230
  v_cvt_pk_bf16_f32 v231, v231, v231
  v_and_b32 v224, 0xffff0000, v223
  v_lshlrev_b32 v223, 16, v223
  v_and_b32 v226, 0xffff0000, v225
  v_lshlrev_b32 v225, 16, v225
  v_and_b32 v228, 0xffff0000, v227
  v_lshlrev_b32 v227, 16, v227
  v_and_b32 v230, 0xffff0000, v229
  v_lshlrev_b32 v229, 16, v229
  v_lshlrev_b32 v231, 16, v231
  v_mul_f32 v232, v223, v223
  v_mul_f32 v233, v224, v224
  v_mul_f32 v234, v225, v225
  v_mul_f32 v235, v226, v226
  v_mul_f32 v236, v227, v227
  v_mul_f32 v237, v228, v228
  v_mul_f32 v238, v229, v229
  v_mul_f32 v239, v230, v230
  v_mul_f32 v240, v231, v231
  v_fmaak_f32 v232, v13, v232, 0xc0135761
  v_fmaak_f32 v233, v13, v233, 0xc0135761
  v_fmaak_f32 v234, v13, v234, 0xc0135761
  v_fmaak_f32 v235, v13, v235, 0xc0135761
  v_fmaak_f32 v236, v13, v236, 0xc0135761
  v_fmaak_f32 v237, v13, v237, 0xc0135761
  v_fmaak_f32 v238, v13, v238, 0xc0135761
  v_fmaak_f32 v239, v13, v239, 0xc0135761
  v_fmaak_f32 v240, v13, v240, 0xc0135761
  v_mul_f32 v232, v232, v223
  v_mul_f32 v233, v233, v224
  v_mul_f32 v234, v234, v225
  v_mul_f32 v235, v235, v226
  v_mul_f32 v236, v236, v227
  v_mul_f32 v237, v237, v228
  v_mul_f32 v238, v238, v229
  v_mul_f32 v239, v239, v230
  v_mul_f32 v240, v240, v231
  v_exp_f32 v232, v232
  v_exp_f32 v233, v233
  v_exp_f32 v234, v234
  v_exp_f32 v235, v235
  v_exp_f32 v236, v236
  v_exp_f32 v237, v237
  v_exp_f32 v238, v238
  v_exp_f32 v239, v239
  v_exp_f32 v240, v240
  v_add_f32 v232, 1.0, v232
  v_add_f32 v233, 1.0, v233
  v_add_f32 v234, 1.0, v234
  v_add_f32 v235, 1.0, v235
  v_add_f32 v236, 1.0, v236
  v_add_f32 v237, 1.0, v237
  v_add_f32 v238, 1.0, v238
  v_add_f32 v239, 1.0, v239
  v_add_f32 v240, 1.0, v240
  v_rcp_f32 v232, v232
  v_rcp_f32 v233, v233
  v_rcp_f32 v234, v234
  v_rcp_f32 v235, v235
  v_rcp_f32 v236, v236
  v_rcp_f32 v237, v237
  v_rcp_f32 v238, v238
  v_rcp_f32 v239, v239
  v_rcp_f32 v240, v240
  v_mul_f32 v223, v223, v232
  v_mul_f32 v224, v224, v233
  v_mul_f32 v225, v225, v234
  v_mul_f32 v226, v226, v235
  v_mul_f32 v227, v227, v236
  v_mul_f32 v228, v228, v237
  v_mul_f32 v229, v229, v238
  v_mul_f32 v230, v230, v239
  v_mul_f32 v231, v231, v240
  v_cvt_pk_bf16_f32 v223, v223, v224
  v_cvt_pk_bf16_f32 v225, v225, v226
  v_cvt_pk_bf16_f32 v227, v227, v228
  v_cvt_pk_bf16_f32 v229, v229, v230
  v_cvt_pk_bf16_f32 v231, v231, v231
  v_and_b32 v224, 0xffff0000, v223
  v_lshlrev_b32 v223, 16, v223
  v_and_b32 v226, 0xffff0000, v225
  v_lshlrev_b32 v225, 16, v225
  v_and_b32 v228, 0xffff0000, v227
  v_lshlrev_b32 v227, 16, v227
  v_and_b32 v230, 0xffff0000, v229
  v_lshlrev_b32 v229, 16, v229
  v_lshlrev_b32 v231, 16, v231
  v_fmac_f32 v214, v223, v213
  v_fmac_f32 v215, v224, v213
  v_fmac_f32 v216, v225, v213
  v_fmac_f32 v217, v226, v213
  v_fmac_f32 v218, v227, v213
  v_fmac_f32 v219, v228, v213
  v_fmac_f32 v220, v229, v213
  v_fmac_f32 v221, v230, v213
  v_fmac_f32 v222, v231, v213
  v_add_f32_dpp v214, v214, v214 quad_perm:[1,0,3,2] row_mask:0xf bank_mask:0xf
  v_add_f32_dpp v215, v215, v215 quad_perm:[1,0,3,2] row_mask:0xf bank_mask:0xf
  v_add_f32_dpp v216, v216, v216 quad_perm:[1,0,3,2] row_mask:0xf bank_mask:0xf
  v_add_f32_dpp v217, v217, v217 quad_perm:[1,0,3,2] row_mask:0xf bank_mask:0xf
  v_add_f32_dpp v218, v218, v218 quad_perm:[1,0,3,2] row_mask:0xf bank_mask:0xf
  v_add_f32_dpp v219, v219, v219 quad_perm:[1,0,3,2] row_mask:0xf bank_mask:0xf
  v_add_f32_dpp v220, v220, v220 quad_perm:[1,0,3,2] row_mask:0xf bank_mask:0xf
  v_add_f32_dpp v221, v221, v221 quad_perm:[1,0,3,2] row_mask:0xf bank_mask:0xf
  v_add_f32_dpp v222, v222, v222 quad_perm:[1,0,3,2] row_mask:0xf bank_mask:0xf
  v_add_f32_dpp v214, v214, v214 quad_perm:[2,3,0,1] row_mask:0xf bank_mask:0xf
  v_add_f32_dpp v215, v215, v215 quad_perm:[2,3,0,1] row_mask:0xf bank_mask:0xf
  v_add_f32_dpp v216, v216, v216 quad_perm:[2,3,0,1] row_mask:0xf bank_mask:0xf
  v_add_f32_dpp v217, v217, v217 quad_perm:[2,3,0,1] row_mask:0xf bank_mask:0xf
  v_add_f32_dpp v218, v218, v218 quad_perm:[2,3,0,1] row_mask:0xf bank_mask:0xf
  v_add_f32_dpp v219, v219, v219 quad_perm:[2,3,0,1] row_mask:0xf bank_mask:0xf
  v_add_f32_dpp v220, v220, v220 quad_perm:[2,3,0,1] row_mask:0xf bank_mask:0xf
  v_add_f32_dpp v221, v221, v221 quad_perm:[2,3,0,1] row_mask:0xf bank_mask:0xf
  v_add_f32_dpp v222, v222, v222 quad_perm:[2,3,0,1] row_mask:0xf bank_mask:0xf
  v_add_f32_dpp v214, v214, v214 row_half_mirror row_mask:0xf bank_mask:0xf
  v_add_f32_dpp v215, v215, v215 row_half_mirror row_mask:0xf bank_mask:0xf
  v_add_f32_dpp v216, v216, v216 row_half_mirror row_mask:0xf bank_mask:0xf
  v_add_f32_dpp v217, v217, v217 row_half_mirror row_mask:0xf bank_mask:0xf
  v_add_f32_dpp v218, v218, v218 row_half_mirror row_mask:0xf bank_mask:0xf
  v_add_f32_dpp v219, v219, v219 row_half_mirror row_mask:0xf bank_mask:0xf
  v_add_f32_dpp v220, v220, v220 row_half_mirror row_mask:0xf bank_mask:0xf
  v_add_f32_dpp v221, v221, v221 row_half_mirror row_mask:0xf bank_mask:0xf
  v_add_f32_dpp v222, v222, v222 row_half_mirror row_mask:0xf bank_mask:0xf
  v_add_f32_dpp v214, v214, v214 row_mirror row_mask:0xf bank_mask:0xf
  v_add_f32_dpp v215, v215, v215 row_mirror row_mask:0xf bank_mask:0xf
  v_add_f32_dpp v216, v216, v216 row_mirror row_mask:0xf bank_mask:0xf
  v_add_f32_dpp v217, v217, v217 row_mirror row_mask:0xf bank_mask:0xf
  v_add_f32_dpp v218, v218, v218 row_mirror row_mask:0xf bank_mask:0xf
  v_add_f32_dpp v219, v219, v219 row_mirror row_mask:0xf bank_mask:0xf
  v_add_f32_dpp v220, v220, v220 row_mirror row_mask:0xf bank_mask:0xf
  v_add_f32_dpp v221, v221, v221 row_mirror row_mask:0xf bank_mask:0xf
  v_add_f32_dpp v222, v222, v222 row_mirror row_mask:0xf bank_mask:0xf
  v_mov_b32 v223, v214
  v_mov_b32 v224, v215
  v_mov_b32 v225, v216
  v_mov_b32 v226, v217
  v_mov_b32 v227, v218
  v_mov_b32 v228, v219
  v_mov_b32 v229, v220
  v_mov_b32 v230, v221
  v_mov_b32 v231, v222
  v_permlane16_swap_b32 v223, v214
  v_permlane16_swap_b32 v224, v215
  v_permlane16_swap_b32 v225, v216
  v_permlane16_swap_b32 v226, v217
  v_permlane16_swap_b32 v227, v218
  v_permlane16_swap_b32 v228, v219
  v_permlane16_swap_b32 v229, v220
  v_permlane16_swap_b32 v230, v221
  v_permlane16_swap_b32 v231, v222
  v_add_f32 v214, v214, v223
  v_add_f32 v215, v215, v224
  v_add_f32 v216, v216, v225
  v_add_f32 v217, v217, v226
  v_add_f32 v218, v218, v227
  v_add_f32 v219, v219, v228
  v_add_f32 v220, v220, v229
  v_add_f32 v221, v221, v230
  v_add_f32 v222, v222, v231
  v_mov_b32 v223, v214
  v_mov_b32 v224, v215
  v_mov_b32 v225, v216
  v_mov_b32 v226, v217
  v_mov_b32 v227, v218
  v_mov_b32 v228, v219
  v_mov_b32 v229, v220
  v_mov_b32 v230, v221
  v_mov_b32 v231, v222
  v_permlane32_swap_b32 v223, v214
  v_permlane32_swap_b32 v224, v215
  v_permlane32_swap_b32 v225, v216
  v_permlane32_swap_b32 v226, v217
  v_permlane32_swap_b32 v227, v218
  v_permlane32_swap_b32 v228, v219
  v_permlane32_swap_b32 v229, v220
  v_permlane32_swap_b32 v230, v221
  v_permlane32_swap_b32 v231, v222
  v_add_f32 v214, v214, v223
  v_add_f32 v215, v215, v224
  v_add_f32 v216, v216, v225
  v_add_f32 v217, v217, v226
  v_add_f32 v218, v218, v227
  v_add_f32 v219, v219, v228
  v_add_f32 v220, v220, v229
  v_add_f32 v221, v221, v230
  v_add_f32 v222, v222, v231
  s_lshl_b32 s9, s3, 6
  s_add_u32 s9, s9, 95616
  v_mov_b32 v4, s9
  s_mov_b64 exec, 1
  ds_write_b32 v4, v214 offset:0
  ds_write_b32 v4, v215 offset:4
  ds_write_b32 v4, v216 offset:8
  ds_write_b32 v4, v217 offset:12
  ds_write_b32 v4, v218 offset:16
  ds_write_b32 v4, v219 offset:20
  ds_write_b32 v4, v220 offset:24
  ds_write_b32 v4, v221 offset:28
  ds_write_b32 v4, v222 offset:32
  s_mov_b64 exec, -1
  s_waitcnt vmcnt(5)
  s_cmp_eq_u32 s36, 1
  s_cbranch_scc1 L_att_3
  s_cmp_eq_u32 s37, 0
  s_cbranch_scc1 L_att_3
  v_max_u32 v249, v244, v245
  v_max3_u32 v249, v249, v246, v247
  v_cmp_eq_u32 vcc, -1, v249
  s_nop 1
  s_cmp_eq_u64 vcc, 0
  s_cbranch_scc0 L_att_3
  s_lshl_b32 s9, s3, 10
  s_add_u32 s9, s9, 96256
  v_lshl_add_u32 v4, v1, 4, s9
  ds_write_b128 v4, v[244:247]
  v_mov_b32 v4, 104448
  v_mov_b32 v5, 1
  s_waitcnt lgkmcnt(0)
  s_mov_b64 exec, 1
  ds_add_u32 v4, v5 offset:4
  s_mov_b64 exec, -1
  s_mov_b32 s36, 1
L_att_3:
  s_nop 7
  v_cmp_eq_u32 vcc, 0x01010101, v248
  s_nop 1
  s_and_b64 s[98:99], vcc, s[38:39]
  s_cmp_eq_u64 s[98:99], s[38:39]
  s_cselect_b32 s37, 1, 0
  s_cmp_eq_u32 s36, 1
  s_cbranch_scc1 L_q_have
  s_mov_b32 s94, 0
L_poll_4:
  s_nop 7
  buffer_load_dword v248, v9, s[84:87], 0 offen sc0 sc1
  s_waitcnt vmcnt(0)
  v_cmp_eq_u32 vcc, 0x01010101, v248
  s_nop 1
  s_and_b64 s[98:99], vcc, s[38:39]
  s_cmp_eq_u64 s[98:99], s[38:39]
  s_cbranch_scc1 L_polldone_5
  s_add_u32 s94, s94, 1
  s_cmp_gt_u32 s94, 400000
  s_cbranch_scc1 L_polldone_5
  s_sleep 1
  s_branch L_poll_4
L_polldone_5:
  s_nop 7
  s_mov_b32 s94, 0
L_poll_6:
  s_nop 7
  buffer_load_dwordx4 v[244:247], v10, s[88:91], s40 offen sc0 sc1
  s_waitcnt vmcnt(0)
  v_max_u32 v249, v244, v245
  v_max3_u32 v249, v249, v246, v247
  v_cmp_eq_u32 vcc, -1, v249
  s_nop 1
  s_cmp_eq_u64 vcc, 0
  s_cbranch_scc1 L_polldone_7
  s_add_u32 s94, s94, 1
  s_cmp_gt_u32 s94, 400000
  s_cbranch_scc1 L_polldone_7
  s_sleep 1
  s_branch L_poll_6
L_polldone_7:
  s_nop 7
  s_lshl_b32 s9, s3, 10
  s_add_u32 s9, s9, 96256
  v_lshl_add_u32 v4, v1, 4, s9
  ds_write_b128 v4, v[244:247]
  v_mov_b32 v4, 104448
  v_mov_b32 v5, 1
  s_waitcnt lgkmcnt(0)
  s_mov_b64 exec, 1
  ds_add_u32 v4, v5 offset:4
  s_mov_b64 exec, -1
  s_mov_b32 s36, 1
L_q_have:
  s_nop 7
  v_mov_b32 v4, 104448
  s_mov_b32 s94, 0
L_qf_spin:
  s_nop 7
  ds_read_b32 v5, v4 offset:4
  s_waitcnt lgkmcnt(0)
  v_readfirstlane_b32 s95, v5
  s_nop 1
  s_cmp_ge_u32 s95, 8
  s_cbranch_scc1 L_q_ready
  s_add_u32 s94, s94, 1
  s_cmp_gt_u32 s94, 3200000
  s_cbranch_scc1 L_q_ready
  s_sleep 1
  s_branch L_qf_spin
L_q_ready:
  s_nop 7
  v_bfe_u32 v4, v1, 2, 1
  v_lshlrev_b32 v4, 9, v4
  v_and_b32 v5, 3, v1
  v_lshl_add_u32 v4, v5, 5, v4
  v_lshrrev_b32 v5, 4, v1
  v_lshl_add_u32 v4, v5, 7, v4
  v_add_u32 v4, 96256, v4
  ds_read_b128 v[196:199], v4 offset:0
  ds_read_b128 v[200:203], v4 offset:1024
  ds_read_b128 v[204:207], v4 offset:2048
  ds_read_b128 v[208:211], v4 offset:3072
  ds_read_b128 v[212:215], v4 offset:4096
  ds_read_b128 v[216:219], v4 offset:5120
  ds_read_b128 v[220:223], v4 offset:6144
  ds_read_b128 v[224:227], v4 offset:7168
  s_waitcnt lgkmcnt(0)
  v_add_f32 v196, v196, v212
  v_add_f32 v197, v197, v213
  v_add_f32 v198, v198, v214
  v_add_f32 v199, v199, v215
  v_add_f32 v200, v200, v216
  v_add_f32 v201, v201, v217
  v_add_f32 v202, v202, v218
  v_add_f32 v203, v203, v219
  v_add_f32 v204, v204, v220
  v_add_f32 v205, v205, v221
  v_add_f32 v206, v206, v222
  v_add_f32 v207, v207, v223
  v_add_f32 v208, v208, v224
  v_add_f32 v209, v209, v225
  v_add_f32 v210, v210, v226
  v_add_f32 v211, v211, v227
  v_add_f32 v196, v196, v204
  v_add_f32 v197, v197, v205
  v_add_f32 v198, v198, v206
  v_add_f32 v199, v199, v207
  v_add_f32 v200, v200, v208
  v_add_f32 v201, v201, v209
  v_add_f32 v202, v202, v210
  v_add_f32 v203, v203, v211
  v_add_f32 v196, v196, v200
  v_add_f32 v197, v197, v201
  v_add_f32 v198, v198, v202
  v_add_f32 v199, v199, v203
  v_cvt_pk_bf16_f32 v192, v196, v197
  v_cvt_pk_bf16_f32 v193, v198, v199
  ds_read_b128 v[196:199], v4 offset:16
  ds_read_b128 v[200:203], v4 offset:1040
  ds_read_b128 v[204:207], v4 offset:2064
  ds_read_b128 v[208:211], v4 offset:3088
  ds_read_b128 v[212:215], v4 offset:4112
  ds_read_b128 v[216:219], v4 offset:5136
  ds_read_b128 v[220:223], v4 offset:6160
  ds_read_b128 v[224:227], v4 offset:7184
  s_waitcnt lgkmcnt(0)
  v_add_f32 v196, v196, v212
  v_add_f32 v197, v197, v213
  v_add_f32 v198, v198, v214
  v_add_f32 v199, v199, v215
  v_add_f32 v200, v200, v216
  v_add_f32 v201, v201, v217
  v_add_f32 v202, v202, v218
  v_add_f32 v203, v203, v219
  v_add_f32 v204, v204, v220
  v_add_f32 v205, v205, v221
  v_add_f32 v206, v206, v222
  v_add_f32 v207, v207, v223
  v_add_f32 v208, v208, v224
  v_add_f32 v209, v209, v225
  v_add_f32 v210, v210, v226
  v_add_f32 v211, v211, v227
  v_add_f32 v196, v196, v204
  v_add_f32 v197, v197, v205
  v_add_f32 v198, v198, v206
  v_add_f32 v199, v199, v207
  v_add_f32 v200, v200, v208
  v_add_f32 v201, v201, v209
  v_add_f32 v202, v202, v210
  v_add_f32 v203, v203, v211
  v_add_f32 v196, v196, v200
  v_add_f32 v197, v197, v201
  v_add_f32 v198, v198, v202
  v_add_f32 v199, v199, v203
  v_cvt_pk_bf16_f32 v194, v196, v197
  v_cvt_pk_bf16_f32 v195, v198, v199
  v_add_u32 v12, s42, v3
  s_add_u32 s9, s41, 106496
  v_add_u32 v11, s9, v3
  v_mfma_f32_16x16x32_bf16 v[176:179], v[116:119], v[192:195], 0
  v_mfma_f32_16x16x32_bf16 v[180:183], v[120:123], v[192:195], 0
  v_mfma_f32_16x16x32_bf16 v[184:187], v[124:127], v[192:195], 0
  s_nop 5
  v_cndmask_b32 v176, v176, v177, s[12:13]
  v_cndmask_b32 v178, v178, v179, s[12:13]
  v_cndmask_b32 v176, v176, v178, s[14:15]
  s_nop 1
  v_add_f32_dpp v176, v176, v176 quad_perm:[1,0,3,2] row_mask:0xf bank_mask:0xf
  s_nop 1
  v_add_f32_dpp v112, v176, v176 quad_perm:[2,3,0,1] row_mask:0xf bank_mask:0xf
  v_mfma_f32_16x16x32_bf16 v[188:191], v[128:131], v[192:195], 0
  v_cndmask_b32 v180, v180, v181, s[12:13]
  v_cndmask_b32 v182, v182, v183, s[12:13]
  v_cndmask_b32 v180, v180, v182, s[14:15]
  s_nop 1
  v_add_f32_dpp v180, v180, v180 quad_perm:[1,0,3,2] row_mask:0xf bank_mask:0xf
  s_nop 1
  v_add_f32_dpp v113, v180, v180 quad_perm:[2,3,0,1] row_mask:0xf bank_mask:0xf
  v_mfma_f32_16x16x32_bf16 v[176:179], v[132:135], v[192:195], 0
  v_cndmask_b32 v184, v184, v185, s[12:13]
  v_cndmask_b32 v186, v186, v187, s[12:13]
  v_cndmask_b32 v184, v184, v186, s[14:15]
  s_nop 1
  v_add_f32_dpp v184, v184, v184 quad_perm:[1,0,3,2] row_mask:0xf bank_mask:0xf
  s_nop 1
  v_add_f32_dpp v114, v184, v184 quad_perm:[2,3,0,1] row_mask:0xf bank_mask:0xf
  v_mfma_f32_16x16x32_bf16 v[180:183], v[136:139], v[192:195], 0
  v_cndmask_b32 v188, v188, v189, s[12:13]
  v_cndmask_b32 v190, v190, v191, s[12:13]
  v_cndmask_b32 v188, v188, v190, s[14:15]
  s_nop 1
  v_add_f32_dpp v188, v188, v188 quad_perm:[1,0,3,2] row_mask:0xf bank_mask:0xf
  s_nop 1
  v_add_f32_dpp v115, v188, v188 quad_perm:[2,3,0,1] row_mask:0xf bank_mask:0xf
  v_mfma_f32_16x16x32_bf16 v[184:187], v[140:143], v[192:195], 0
  v_cndmask_b32 v176, v176, v177, s[12:13]
  v_cndmask_b32 v178, v178, v179, s[12:13]
  v_cndmask_b32 v176, v176, v178, s[14:15]
  s_nop 1
  v_add_f32_dpp v176, v176, v176 quad_perm:[1,0,3,2] row_mask:0xf bank_mask:0xf
  s_nop 1
  v_add_f32_dpp v116, v176, v176 quad_perm:[2,3,0,1] row_mask:0xf bank_mask:0xf
  v_mfma_f32_16x16x32_bf16 v[188:191], v[144:147], v[192:195], 0
  v_cndmask_b32 v180, v180, v181, s[12:13]
  v_cndmask_b32 v182, v182, v183, s[12:13]
  v_cndmask_b32 v180, v180, v182, s[14:15]
  s_nop 1
  v_add_f32_dpp v180, v180, v180 quad_perm:[1,0,3,2] row_mask:0xf bank_mask:0xf
  s_nop 1
  v_add_f32_dpp v117, v180, v180 quad_perm:[2,3,0,1] row_mask:0xf bank_mask:0xf
  v_mfma_f32_16x16x32_bf16 v[176:179], v[148:151], v[192:195], 0
  v_cndmask_b32 v184, v184, v185, s[12:13]
  v_cndmask_b32 v186, v186, v187, s[12:13]
  v_cndmask_b32 v184, v184, v186, s[14:15]
  s_nop 1
  v_add_f32_dpp v184, v184, v184 quad_perm:[1,0,3,2] row_mask:0xf bank_mask:0xf
  s_nop 1
  v_add_f32_dpp v118, v184, v184 quad_perm:[2,3,0,1] row_mask:0xf bank_mask:0xf
  v_mfma_f32_16x16x32_bf16 v[180:183], v[152:155], v[192:195], 0
  v_cndmask_b32 v188, v188, v189, s[12:13]
  v_cndmask_b32 v190, v190, v191, s[12:13]
  v_cndmask_b32 v188, v188, v190, s[14:15]
  s_nop 1
  v_add_f32_dpp v188, v188, v188 quad_perm:[1,0,3,2] row_mask:0xf bank_mask:0xf
  s_nop 1
  v_add_f32_dpp v119, v188, v188 quad_perm:[2,3,0,1] row_mask:0xf bank_mask:0xf
  v_mfma_f32_16x16x32_bf16 v[184:187], v[156:159], v[192:195], 0
  v_cndmask_b32 v176, v176, v177, s[12:13]
  v_cndmask_b32 v178, v178, v179, s[12:13]
  v_cndmask_b32 v176, v176, v178, s[14:15]
  s_nop 1
  v_add_f32_dpp v176, v176, v176 quad_perm:[1,0,3,2] row_mask:0xf bank_mask:0xf
  s_nop 1
  v_add_f32_dpp v120, v176, v176 quad_perm:[2,3,0,1] row_mask:0xf bank_mask:0xf
  v_mfma_f32_16x16x32_bf16 v[188:191], v[160:163], v[192:195], 0
  v_cndmask_b32 v180, v180, v181, s[12:13]
  v_cndmask_b32 v182, v182, v183, s[12:13]
  v_cndmask_b32 v180, v180, v182, s[14:15]
  s_nop 1
  v_add_f32_dpp v180, v180, v180 quad_perm:[1,0,3,2] row_mask:0xf bank_mask:0xf
  s_nop 1
  v_add_f32_dpp v121, v180, v180 quad_perm:[2,3,0,1] row_mask:0xf bank_mask:0xf
  v_mfma_f32_16x16x32_bf16 v[176:179], v[164:167], v[192:195], 0
  v_cndmask_b32 v184, v184, v185, s[12:13]
  v_cndmask_b32 v186, v186, v187, s[12:13]
  v_cndmask_b32 v184, v184, v186, s[14:15]
  s_nop 1
  v_add_f32_dpp v184, v184, v184 quad_perm:[1,0,3,2] row_mask:0xf bank_mask:0xf
  s_nop 1
  v_add_f32_dpp v122, v184, v184 quad_perm:[2,3,0,1] row_mask:0xf bank_mask:0xf
  v_mfma_f32_16x16x32_bf16 v[180:183], v[168:171], v[192:195], 0
  v_cndmask_b32 v188, v188, v189, s[12:13]
  v_cndmask_b32 v190, v190, v191, s[12:13]
  v_cndmask_b32 v188, v188, v190, s[14:15]
  s_nop 1
  v_add_f32_dpp v188, v188, v188 quad_perm:[1,0,3,2] row_mask:0xf bank_mask:0xf
  s_nop 1
  v_add_f32_dpp v123, v188, v188 quad_perm:[2,3,0,1] row_mask:0xf bank_mask:0xf
  v_mfma_f32_16x16x32_bf16 v[184:187], v[172:175], v[192:195], 0
  v_cndmask_b32 v176, v176, v177, s[12:13]
  v_cndmask_b32 v178, v178, v179, s[12:13]
  v_cndmask_b32 v176, v176, v178, s[14:15]
  s_nop 1
  v_add_f32_dpp v176, v176, v176 quad_perm:[1,0,3,2] row_mask:0xf bank_mask:0xf
  s_nop 1
  v_add_f32_dpp v124, v176, v176 quad_perm:[2,3,0,1] row_mask:0xf bank_mask:0xf
  v_mfma_f32_16x16x32_bf16 v[188:191], v[16:19], v[192:195], 0
  s_add_u32 s9, s8, 425984
  buffer_load_dwordx4 v[16:19], v2, s[44:47], s9 offen offset:2048 nt
  v_cndmask_b32 v180, v180, v181, s[12:13]
  v_cndmask_b32 v182, v182, v183, s[12:13]
  v_cndmask_b32 v180, v180, v182, s[14:15]
  s_nop 1
  v_add_f32_dpp v180, v180, v180 quad_perm:[1,0,3,2] row_mask:0xf bank_mask:0xf
  s_nop 1
  v_add_f32_dpp v125, v180, v180 quad_perm:[2,3,0,1] row_mask:0xf bank_mask:0xf
  v_mfma_f32_16x16x32_bf16 v[176:179], v[20:23], v[192:195], 0
  s_add_u32 s9, s8, 425984
  buffer_load_dwordx4 v[20:23], v2, s[44:47], s9 offen offset:3072 nt
  v_cndmask_b32 v184, v184, v185, s[12:13]
  v_cndmask_b32 v186, v186, v187, s[12:13]
  v_cndmask_b32 v184, v184, v186, s[14:15]
  s_nop 1
  v_add_f32_dpp v184, v184, v184 quad_perm:[1,0,3,2] row_mask:0xf bank_mask:0xf
  s_nop 1
  v_add_f32_dpp v126, v184, v184 quad_perm:[2,3,0,1] row_mask:0xf bank_mask:0xf
  v_mfma_f32_16x16x32_bf16 v[180:183], v[24:27], v[192:195], 0
  s_add_u32 s9, s8, 458752
  buffer_load_dwordx4 v[24:27], v2, s[44:47], s9 offen offset:0 nt
  v_cndmask_b32 v188, v188, v189, s[12:13]
  v_cndmask_b32 v190, v190, v191, s[12:13]
  v_cndmask_b32 v188, v188, v190, s[14:15]
  s_nop 1
  v_add_f32_dpp v188, v188, v188 quad_perm:[1,0,3,2] row_mask:0xf bank_mask:0xf
  s_nop 1
  v_add_f32_dpp v127, v188, v188 quad_perm:[2,3,0,1] row_mask:0xf bank_mask:0xf
  v_mfma_f32_16x16x32_bf16 v[184:187], v[28:31], v[192:195], 0
  s_add_u32 s9, s8, 458752
  buffer_load_dwordx4 v[28:31], v2, s[44:47], s9 offen offset:1024 nt
  v_cndmask_b32 v176, v176, v177, s[12:13]
  v_cndmask_b32 v178, v178, v179, s[12:13]
  v_cndmask_b32 v176, v176, v178, s[14:15]
  s_nop 1
  v_add_f32_dpp v176, v176, v176 quad_perm:[1,0,3,2] row_mask:0xf bank_mask:0xf
  s_nop 1
  v_add_f32_dpp v128, v176, v176 quad_perm:[2,3,0,1] row_mask:0xf bank_mask:0xf
  v_mfma_f32_16x16x32_bf16 v[188:191], v[32:35], v[192:195], 0
  s_add_u32 s9, s8, 458752
  buffer_load_dwordx4 v[32:35], v2, s[44:47], s9 offen offset:2048 nt
  v_cndmask_b32 v180, v180, v181, s[12:13]
  v_cndmask_b32 v182, v182, v183, s[12:13]
  v_cndmask_b32 v180, v180, v182, s[14:15]
  s_nop 1
  v_add_f32_dpp v180, v180, v180 quad_perm:[1,0,3,2] row_mask:0xf bank_mask:0xf
  s_nop 1
  v_add_f32_dpp v129, v180, v180 quad_perm:[2,3,0,1] row_mask:0xf bank_mask:0xf
  v_mfma_f32_16x16x32_bf16 v[176:179], v[36:39], v[192:195], 0
  s_add_u32 s9, s8, 458752
  buffer_load_dwordx4 v[36:39], v2, s[44:47], s9 offen offset:3072 nt
  v_cndmask_b32 v184, v184, v185, s[12:13]
  v_cndmask_b32 v186, v186, v187, s[12:13]
  v_cndmask_b32 v184, v184, v186, s[14:15]
  s_nop 1
  v_add_f32_dpp v184, v184, v184 quad_perm:[1,0,3,2] row_mask:0xf bank_mask:0xf
  s_nop 1
  v_add_f32_dpp v130, v184, v184 quad_perm:[2,3,0,1] row_mask:0xf bank_mask:0xf
  v_mfma_f32_16x16x32_bf16 v[180:183], v[40:43], v[192:195], 0
  s_add_u32 s9, s8, 491520
  buffer_load_dwordx4 v[40:43], v2, s[44:47], s9 offen offset:0 nt
  v_cndmask_b32 v188, v188, v189, s[12:13]
  v_cndmask_b32 v190, v190, v191, s[12:13]
  v_cndmask_b32 v188, v188, v190, s[14:15]
  s_nop 1
  v_add_f32_dpp v188, v188, v188 quad_perm:[1,0,3,2] row_mask:0xf bank_mask:0xf
  s_nop 1
  v_add_f32_dpp v131, v188, v188 quad_perm:[2,3,0,1] row_mask:0xf bank_mask:0xf
  v_mfma_f32_16x16x32_bf16 v[184:187], v[44:47], v[192:195], 0
  s_add_u32 s9, s8, 491520
  buffer_load_dwordx4 v[44:47], v2, s[44:47], s9 offen offset:1024 nt
  v_cndmask_b32 v176, v176, v177, s[12:13]
  v_cndmask_b32 v178, v178, v179, s[12:13]
  v_cndmask_b32 v176, v176, v178, s[14:15]
  s_nop 1
  v_add_f32_dpp v176, v176, v176 quad_perm:[1,0,3,2] row_mask:0xf bank_mask:0xf
  s_nop 1
  v_add_f32_dpp v132, v176, v176 quad_perm:[2,3,0,1] row_mask:0xf bank_mask:0xf
  v_mfma_f32_16x16x32_bf16 v[188:191], v[48:51], v[192:195], 0
  s_add_u32 s9, s8, 491520
  buffer_load_dwordx4 v[48:51], v2, s[44:47], s9 offen offset:2048 nt
  v_cndmask_b32 v180, v180, v181, s[12:13]
  v_cndmask_b32 v182, v182, v183, s[12:13]
  v_cndmask_b32 v180, v180, v182, s[14:15]
  s_nop 1
  v_add_f32_dpp v180, v180, v180 quad_perm:[1,0,3,2] row_mask:0xf bank_mask:0xf
  s_nop 1
  v_add_f32_dpp v133, v180, v180 quad_perm:[2,3,0,1] row_mask:0xf bank_mask:0xf
  v_mfma_f32_16x16x32_bf16 v[176:179], v[52:55], v[192:195], 0
  s_add_u32 s9, s8, 491520
  buffer_load_dwordx4 v[52:55], v2, s[44:47], s9 offen offset:3072 nt
  v_cndmask_b32 v184, v184, v185, s[12:13]
  v_cndmask_b32 v186, v186, v187, s[12:13]
  v_cndmask_b32 v184, v184, v186, s[14:15]
  s_nop 1
  v_add_f32_dpp v184, v184, v184 quad_perm:[1,0,3,2] row_mask:0xf bank_mask:0xf
  s_nop 1
  v_add_f32_dpp v134, v184, v184 quad_perm:[2,3,0,1] row_mask:0xf bank_mask:0xf
  v_mfma_f32_16x16x32_bf16 v[180:183], v[56:59], v[192:195], 0
  s_add_u32 s9, s8, 0
  buffer_load_dwordx4 v[56:59], v3, s[48:51], s9 offen offset:0 nt
  v_cndmask_b32 v188, v188, v189, s[12:13]
  v_cndmask_b32 v190, v190, v191, s[12:13]
  v_cndmask_b32 v188, v188, v190, s[14:15]
  s_nop 1
  v_add_f32_dpp v188, v188, v188 quad_perm:[1,0,3,2] row_mask:0xf bank_mask:0xf
  s_nop 1
  v_add_f32_dpp v135, v188, v188 quad_perm:[2,3,0,1] row_mask:0xf bank_mask:0xf
  v_mfma_f32_16x16x32_bf16 v[184:187], v[60:63], v[192:195], 0
  s_add_u32 s9, s8, 0
  buffer_load_dwordx4 v[60:63], v3, s[48:51], s9 offen offset:1024 nt
  v_cndmask_b32 v176, v176, v177, s[12:13]
  v_cndmask_b32 v178, v178, v179, s[12:13]
  v_cndmask_b32 v176, v176, v178, s[14:15]
  s_nop 1
  v_add_f32_dpp v176, v176, v176 quad_perm:[1,0,3,2] row_mask:0xf bank_mask:0xf
  s_nop 1
  v_add_f32_dpp v136, v176, v176 quad_perm:[2,3,0,1] row_mask:0xf bank_mask:0xf
  v_mfma_f32_16x16x32_bf16 v[188:191], v[64:67], v[192:195], 0
  s_add_u32 s9, s8, 0
  buffer_load_dwordx4 v[64:67], v3, s[48:51], s9 offen offset:2048 nt
  v_cndmask_b32 v180, v180, v181, s[12:13]
  v_cndmask_b32 v182, v182, v183, s[12:13]
  v_cndmask_b32 v180, v180, v182, s[14:15]
  s_nop 1
  v_add_f32_dpp v180, v180, v180 quad_perm:[1,0,3,2] row_mask:0xf bank_mask:0xf
  s_nop 1
  v_add_f32_dpp v137, v180, v180 quad_perm:[2,3,0,1] row_mask:0xf bank_mask:0xf
  v_mfma_f32_16x16x32_bf16 v[176:179], v[68:71], v[192:195], 0
  s_add_u32 s9, s8, 0
  buffer_load_dwordx4 v[68:71], v3, s[48:51], s9 offen offset:3072 nt
  v_cndmask_b32 v184, v184, v185, s[12:13]
  v_cndmask_b32 v186, v186, v187, s[12:13]
  v_cndmask_b32 v184, v184, v186, s[14:15]
  s_nop 1
  v_add_f32_dpp v184, v184, v184 quad_perm:[1,0,3,2] row_mask:0xf bank_mask:0xf
  s_nop 1
  v_add_f32_dpp v138, v184, v184 quad_perm:[2,3,0,1] row_mask:0xf bank_mask:0xf
  v_mfma_f32_16x16x32_bf16 v[180:183], v[72:75], v[192:195], 0
  s_add_u32 s9, s8, 32768
  buffer_load_dwordx4 v[72:75], v3, s[48:51], s9 offen offset:0 nt
  v_cndmask_b32 v188, v188, v189, s[12:13]
  v_cndmask_b32 v190, v190, v191, s[12:13]
  v_cndmask_b32 v188, v188, v190, s[14:15]
  s_nop 1
  v_add_f32_dpp v188, v188, v188 quad_perm:[1,0,3,2] row_mask:0xf bank_mask:0xf
  s_nop 1
  v_add_f32_dpp v139, v188, v188 quad_perm:[2,3,0,1] row_mask:0xf bank_mask:0xf
  v_mfma_f32_16x16x32_bf16 v[184:187], v[76:79], v[192:195], 0
  s_add_u32 s9, s8, 32768
  buffer_load_dwordx4 v[76:79], v3, s[48:51], s9 offen offset:1024 nt
  v_cndmask_b32 v176, v176, v177, s[12:13]
  v_cndmask_b32 v178, v178, v179, s[12:13]
  v_cndmask_b32 v176, v176, v178, s[14:15]
  s_nop 1
  v_add_f32_dpp v176, v176, v176 quad_perm:[1,0,3,2] row_mask:0xf bank_mask:0xf
  s_nop 1
  v_add_f32_dpp v140, v176, v176 quad_perm:[2,3,0,1] row_mask:0xf bank_mask:0xf
  v_mfma_f32_16x16x32_bf16 v[188:191], v[80:83], v[192:195], 0
  s_add_u32 s9, s8, 32768
  buffer_load_dwordx4 v[80:83], v3, s[48:51], s9 offen offset:2048 nt
  v_cndmask_b32 v180, v180, v181, s[12:13]
  v_cndmask_b32 v182, v182, v183, s[12:13]
  v_cndmask_b32 v180, v180, v182, s[14:15]
  s_nop 1
  v_add_f32_dpp v180, v180, v180 quad_perm:[1,0,3,2] row_mask:0xf bank_mask:0xf
  s_nop 1
  v_add_f32_dpp v141, v180, v180 quad_perm:[2,3,0,1] row_mask:0xf bank_mask:0xf
  v_mfma_f32_16x16x32_bf16 v[176:179], v[84:87], v[192:195], 0
  s_add_u32 s9, s8, 32768
  buffer_load_dwordx4 v[84:87], v3, s[48:51], s9 offen offset:3072 nt
  v_cndmask_b32 v184, v184, v185, s[12:13]
  v_cndmask_b32 v186, v186, v187, s[12:13]
  v_cndmask_b32 v184, v184, v186, s[14:15]
  s_nop 1
  v_add_f32_dpp v184, v184, v184 quad_perm:[1,0,3,2] row_mask:0xf bank_mask:0xf
  s_nop 1
  v_add_f32_dpp v142, v184, v184 quad_perm:[2,3,0,1] row_mask:0xf bank_mask:0xf
  v_mfma_f32_16x16x32_bf16 v[180:183], v[88:91], v[192:195], 0
  s_add_u32 s9, s8, 65536
  buffer_load_dwordx4 v[88:91], v3, s[48:51], s9 offen offset:0 nt
  v_cndmask_b32 v188, v188, v189, s[12:13]
  v_cndmask_b32 v190, v190, v191, s[12:13]
  v_cndmask_b32 v188, v188, v190, s[14:15]
  s_nop 1
  v_add_f32_dpp v188, v188, v188 quad_perm:[1,0,3,2] row_mask:0xf bank_mask:0xf
  s_nop 1
  v_add_f32_dpp v143, v188, v188 quad_perm:[2,3,0,1] row_mask:0xf bank_mask:0xf
  v_mfma_f32_16x16x32_bf16 v[184:187], v[92:95], v[192:195], 0
  s_add_u32 s9, s8, 65536
  buffer_load_dwordx4 v[92:95], v3, s[48:51], s9 offen offset:1024 nt
  v_cndmask_b32 v176, v176, v177, s[12:13]
  v_cndmask_b32 v178, v178, v179, s[12:13]
  v_cndmask_b32 v176, v176, v178, s[14:15]
  s_nop 1
  v_add_f32_dpp v176, v176, v176 quad_perm:[1,0,3,2] row_mask:0xf bank_mask:0xf
  s_nop 1
  v_add_f32_dpp v144, v176, v176 quad_perm:[2,3,0,1] row_mask:0xf bank_mask:0xf
  v_mfma_f32_16x16x32_bf16 v[188:191], v[96:99], v[192:195], 0
  s_add_u32 s9, s8, 65536
  buffer_load_dwordx4 v[96:99], v3, s[48:51], s9 offen offset:2048 nt
  v_cndmask_b32 v180, v180, v181, s[12:13]
  v_cndmask_b32 v182, v182, v183, s[12:13]
  v_cndmask_b32 v180, v180, v182, s[14:15]
  s_nop 1
  v_add_f32_dpp v180, v180, v180 quad_perm:[1,0,3,2] row_mask:0xf bank_mask:0xf
  s_nop 1
  v_add_f32_dpp v145, v180, v180 quad_perm:[2,3,0,1] row_mask:0xf bank_mask:0xf
  v_mfma_f32_16x16x32_bf16 v[176:179], v[100:103], v[192:195], 0
  s_add_u32 s9, s8, 65536
  buffer_load_dwordx4 v[100:103], v3, s[48:51], s9 offen offset:3072 nt
  v_cndmask_b32 v184, v184, v185, s[12:13]
  v_cndmask_b32 v186, v186, v187, s[12:13]
  v_cndmask_b32 v184, v184, v186, s[14:15]
  s_nop 1
  v_add_f32_dpp v184, v184, v184 quad_perm:[1,0,3,2] row_mask:0xf bank_mask:0xf
  s_nop 1
  v_add_f32_dpp v146, v184, v184 quad_perm:[2,3,0,1] row_mask:0xf bank_mask:0xf
  v_mfma_f32_16x16x32_bf16 v[180:183], v[104:107], v[192:195], 0
  s_add_u32 s9, s8, 98304
  buffer_load_dwordx4 v[104:107], v3, s[48:51], s9 offen offset:0 nt
  v_cndmask_b32 v188, v188, v189, s[12:13]
  v_cndmask_b32 v190, v190, v191, s[12:13]
  v_cndmask_b32 v188, v188, v190, s[14:15]
  s_nop 1
  v_add_f32_dpp v188, v188, v188 quad_perm:[1,0,3,2] row_mask:0xf bank_mask:0xf
  s_nop 1
  v_add_f32_dpp v147, v188, v188 quad_perm:[2,3,0,1] row_mask:0xf bank_mask:0xf
  v_mfma_f32_16x16x32_bf16 v[184:187], v[108:111], v[192:195], 0
  s_add_u32 s9, s8, 98304
  buffer_load_dwordx4 v[108:111], v3, s[48:51], s9 offen offset:1024 nt
  v_cndmask_b32 v176, v176, v177, s[12:13]
  v_cndmask_b32 v178, v178, v179, s[12:13]
  v_cndmask_b32 v176, v176, v178, s[14:15]
  s_nop 1
  v_add_f32_dpp v176, v176, v176 quad_perm:[1,0,3,2] row_mask:0xf bank_mask:0xf
  s_nop 1
  v_add_f32_dpp v148, v176, v176 quad_perm:[2,3,0,1] row_mask:0xf bank_mask:0xf
  ds_read_b128 v[248:251], v12 offset:0
  s_waitcnt lgkmcnt(0)
  v_mfma_f32_16x16x32_bf16 v[188:191], v[248:251], v[192:195], 0
  v_cndmask_b32 v180, v180, v181, s[12:13]
  v_cndmask_b32 v182, v182, v183, s[12:13]
  v_cndmask_b32 v180, v180, v182, s[14:15]
  s_nop 1
  v_add_f32_dpp v180, v180, v180 quad_perm:[1,0,3,2] row_mask:0xf bank_mask:0xf
  s_nop 1
  v_add_f32_dpp v149, v180, v180 quad_perm:[2,3,0,1] row_mask:0xf bank_mask:0xf
  ds_read_b128 v[244:247], v12 offset:1024
  s_waitcnt lgkmcnt(0)
  v_mfma_f32_16x16x32_bf16 v[176:179], v[244:247], v[192:195], 0
  v_cndmask_b32 v184, v184, v185, s[12:13]
  v_cndmask_b32 v186, v186, v187, s[12:13]
  v_cndmask_b32 v184, v184, v186, s[14:15]
  s_nop 1
  v_add_f32_dpp v184, v184, v184 quad_perm:[1,0,3,2] row_mask:0xf bank_mask:0xf
  s_nop 1
  v_add_f32_dpp v150, v184, v184 quad_perm:[2,3,0,1] row_mask:0xf bank_mask:0xf
  ds_read_b128 v[248:251], v12 offset:2048
  s_waitcnt lgkmcnt(0)
  v_mfma_f32_16x16x32_bf16 v[180:183], v[248:251], v[192:195], 0
  v_cndmask_b32 v188, v188, v189, s[12:13]
  v_cndmask_b32 v190, v190, v191, s[12:13]
  v_cndmask_b32 v188, v188, v190, s[14:15]
  s_nop 1
  v_add_f32_dpp v188, v188, v188 quad_perm:[1,0,3,2] row_mask:0xf bank_mask:0xf
  s_nop 1
  v_add_f32_dpp v151, v188, v188 quad_perm:[2,3,0,1] row_mask:0xf bank_mask:0xf
  ds_read_b128 v[244:247], v12 offset:3072
  s_waitcnt lgkmcnt(0)
  v_mfma_f32_16x16x32_bf16 v[184:187], v[244:247], v[192:195], 0
  v_cndmask_b32 v176, v176, v177, s[12:13]
  v_cndmask_b32 v178, v178, v179, s[12:13]
  v_cndmask_b32 v176, v176, v178, s[14:15]
  s_nop 1
  v_add_f32_dpp v176, v176, v176 quad_perm:[1,0,3,2] row_mask:0xf bank_mask:0xf
  s_nop 1
  v_add_f32_dpp v152, v176, v176 quad_perm:[2,3,0,1] row_mask:0xf bank_mask:0xf
  ds_read_b128 v[248:251], v12 offset:4096
  s_waitcnt lgkmcnt(0)
  v_mfma_f32_16x16x32_bf16 v[188:191], v[248:251], v[192:195], 0
  v_cndmask_b32 v180, v180, v181, s[12:13]
  v_cndmask_b32 v182, v182, v183, s[12:13]
  v_cndmask_b32 v180, v180, v182, s[14:15]
  s_nop 1
  v_add_f32_dpp v180, v180, v180 quad_perm:[1,0,3,2] row_mask:0xf bank_mask:0xf
  s_nop 1
  v_add_f32_dpp v153, v180, v180 quad_perm:[2,3,0,1] row_mask:0xf bank_mask:0xf
  ds_read_b128 v[244:247], v12 offset:5120
  s_waitcnt lgkmcnt(0)
  v_mfma_f32_16x16x32_bf16 v[176:179], v[244:247], v[192:195], 0
  v_cndmask_b32 v184, v184, v185, s[12:13]
  v_cndmask_b32 v186, v186, v187, s[12:13]
  v_cndmask_b32 v184, v184, v186, s[14:15]
  s_nop 1
  v_add_f32_dpp v184, v184, v184 quad_perm:[1,0,3,2] row_mask:0xf bank_mask:0xf
  s_nop 1
  v_add_f32_dpp v154, v184, v184 quad_perm:[2,3,0,1] row_mask:0xf bank_mask:0xf
  ds_read_b128 v[248:251], v12 offset:6144
  s_waitcnt lgkmcnt(0)
  v_mfma_f32_16x16x32_bf16 v[180:183], v[248:251], v[192:195], 0
  v_cndmask_b32 v188, v188, v189, s[12:13]
  v_cndmask_b32 v190, v190, v191, s[12:13]
  v_cndmask_b32 v188, v188, v190, s[14:15]
  s_nop 1
  v_add_f32_dpp v188, v188, v188 quad_perm:[1,0,3,2] row_mask:0xf bank_mask:0xf
  s_nop 1
  v_add_f32_dpp v155, v188, v188 quad_perm:[2,3,0,1] row_mask:0xf bank_mask:0xf
  ds_read_b128 v[244:247], v12 offset:7168
  s_waitcnt lgkmcnt(0)
  v_mfma_f32_16x16x32_bf16 v[184:187], v[244:247], v[192:195], 0
  v_cndmask_b32 v176, v176, v177, s[12:13]
  v_cndmask_b32 v178, v178, v179, s[12:13]
  v_cndmask_b32 v176, v176, v178, s[14:15]
  s_nop 1
  v_add_f32_dpp v176, v176, v176 quad_perm:[1,0,3,2] row_mask:0xf bank_mask:0xf
  s_nop 1
  v_add_f32_dpp v156, v176, v176 quad_perm:[2,3,0,1] row_mask:0xf bank_mask:0xf
  ds_read_b128 v[248:251], v12 offset:8192
  s_waitcnt lgkmcnt(0)
  v_mfma_f32_16x16x32_bf16 v[188:191], v[248:251], v[192:195], 0
  v_cndmask_b32 v180, v180, v181, s[12:13]
  v_cndmask_b32 v182, v182, v183, s[12:13]
  v_cndmask_b32 v180, v180, v182, s[14:15]
  s_nop 1
  v_add_f32_dpp v180, v180, v180 quad_perm:[1,0,3,2] row_mask:0xf bank_mask:0xf
  s_nop 1
  v_add_f32_dpp v157, v180, v180 quad_perm:[2,3,0,1] row_mask:0xf bank_mask:0xf
  s_mul_i32 s92, s7, 73728
  s_mul_i32 s95, s3, 9216
  s_add_u32 s92, s92, s95
  s_add_u32 s94, s95, 0
  s_mov_b32 m0, s94
  s_nop 0
  buffer_load_dwordx4 v3, s[60:63], s92 offen nt lds
  s_add_u32 s92, s92, 1024
  s_add_u32 s94, s95, 1024
  s_mov_b32 m0, s94
  s_nop 0
  buffer_load_dwordx4 v3, s[60:63], s92 offen nt lds
  s_add_u32 s92, s92, 1024
  s_add_u32 s94, s95, 2048
  s_mov_b32 m0, s94
  s_nop 0
  buffer_load_dwordx4 v3, s[60:63], s92 offen nt lds
  s_add_u32 s92, s92, 1024
  s_add_u32 s94, s95, 3072
  s_mov_b32 m0, s94
  s_nop 0
  buffer_load_dwordx4 v3, s[60:63], s92 offen nt lds
  s_add_u32 s92, s92, 1024
  s_add_u32 s94, s95, 4096
  s_mov_b32 m0, s94
  s_nop 0
  buffer_load_dwordx4 v3, s[60:63], s92 offen nt lds
  s_add_u32 s92, s92, 1024
  s_add_u32 s94, s95, 5120
  s_mov_b32 m0, s94
  s_nop 0
  buffer_load_dwordx4 v3, s[60:63], s92 offen nt lds
  s_add_u32 s92, s92, 1024
  s_add_u32 s94, s95, 6144
  s_mov_b32 m0, s94
  s_nop 0
  buffer_load_dwordx4 v3, s[60:63], s92 offen nt lds
  s_add_u32 s92, s92, 1024
  s_add_u32 s94, s95, 7168
  s_mov_b32 m0, s94
  s_nop 0
  buffer_load_dwordx4 v3, s[60:63], s92 offen nt lds
  s_add_u32 s92, s92, 1024
  s_add_u32 s94, s95, 8192
  s_mov_b32 m0, s94
  s_nop 0
  buffer_load_dwordx4 v3, s[60:63], s92 offen nt lds
  ds_read_b128 v[244:247], v11 offset:0
  s_waitcnt lgkmcnt(0)
  v_mfma_f32_16x16x32_bf16 v[176:179], v[244:247], v[192:195], 0
  v_cndmask_b32 v184, v184, v185, s[12:13]
  v_cndmask_b32 v186, v186, v187, s[12:13]
  v_cndmask_b32 v184, v184, v186, s[14:15]
  s_nop 1
  v_add_f32_dpp v184, v184, v184 quad_perm:[1,0,3,2] row_mask:0xf bank_mask:0xf
  s_nop 1
  v_add_f32_dpp v158, v184, v184 quad_perm:[2,3,0,1] row_mask:0xf bank_mask:0xf
  s_waitcnt vmcnt(37)
  ds_read_b128 v[248:251], v11 offset:1024
  s_waitcnt lgkmcnt(0)
  v_mfma_f32_16x16x32_bf16 v[180:183], v[248:251], v[192:195], 0
  v_cndmask_b32 v188, v188, v189, s[12:13]
  v_cndmask_b32 v190, v190, v191, s[12:13]
  v_cndmask_b32 v188, v188, v190, s[14:15]
  s_nop 1
  v_add_f32_dpp v188, v188, v188 quad_perm:[1,0,3,2] row_mask:0xf bank_mask:0xf
  s_nop 1
  v_add_f32_dpp v159, v188, v188 quad_perm:[2,3,0,1] row_mask:0xf bank_mask:0xf
  s_waitcnt vmcnt(36)
  ds_read_b128 v[244:247], v11 offset:2048
  s_waitcnt lgkmcnt(0)
  v_mfma_f32_16x16x32_bf16 v[184:187], v[244:247], v[192:195], 0
  v_cndmask_b32 v176, v176, v177, s[12:13]
  v_cndmask_b32 v178, v178, v179, s[12:13]
  v_cndmask_b32 v176, v176, v178, s[14:15]
  s_nop 1
  v_add_f32_dpp v176, v176, v176 quad_perm:[1,0,3,2] row_mask:0xf bank_mask:0xf
  s_nop 1
  v_add_f32_dpp v160, v176, v176 quad_perm:[2,3,0,1] row_mask:0xf bank_mask:0xf
  s_waitcnt vmcnt(35)
  ds_read_b128 v[248:251], v11 offset:3072
  s_waitcnt lgkmcnt(0)
  v_mfma_f32_16x16x32_bf16 v[188:191], v[248:251], v[192:195], 0
  v_cndmask_b32 v180, v180, v181, s[12:13]
  v_cndmask_b32 v182, v182, v183, s[12:13]
  v_cndmask_b32 v180, v180, v182, s[14:15]
  s_nop 1
  v_add_f32_dpp v180, v180, v180 quad_perm:[1,0,3,2] row_mask:0xf bank_mask:0xf
  s_nop 1
  v_add_f32_dpp v161, v180, v180 quad_perm:[2,3,0,1] row_mask:0xf bank_mask:0xf
  s_waitcnt vmcnt(34)
  ds_read_b128 v[244:247], v11 offset:4096
  s_waitcnt lgkmcnt(0)
  v_mfma_f32_16x16x32_bf16 v[176:179], v[244:247], v[192:195], 0
  v_cndmask_b32 v184, v184, v185, s[12:13]
  v_cndmask_b32 v186, v186, v187, s[12:13]
  v_cndmask_b32 v184, v184, v186, s[14:15]
  s_nop 1
  v_add_f32_dpp v184, v184, v184 quad_perm:[1,0,3,2] row_mask:0xf bank_mask:0xf
  s_nop 1
  v_add_f32_dpp v162, v184, v184 quad_perm:[2,3,0,1] row_mask:0xf bank_mask:0xf
  s_waitcnt vmcnt(33)
  ds_read_b128 v[248:251], v11 offset:5120
  s_waitcnt lgkmcnt(0)
  v_mfma_f32_16x16x32_bf16 v[180:183], v[248:251], v[192:195], 0
  v_cndmask_b32 v188, v188, v189, s[12:13]
  v_cndmask_b32 v190, v190, v191, s[12:13]
  v_cndmask_b32 v188, v188, v190, s[14:15]
  s_nop 1
  v_add_f32_dpp v188, v188, v188 quad_perm:[1,0,3,2] row_mask:0xf bank_mask:0xf
  s_nop 1
  v_add_f32_dpp v163, v188, v188 quad_perm:[2,3,0,1] row_mask:0xf bank_mask:0xf
  s_waitcnt vmcnt(32)
  v_mfma_f32_16x16x32_bf16 v[184:187], v[16:19], v[192:195], 0
  s_add_u32 s9, s8, 98304
  buffer_load_dwordx4 v[16:19], v3, s[48:51], s9 offen offset:2048 nt
  v_cndmask_b32 v176, v176, v177, s[12:13]
  v_cndmask_b32 v178, v178, v179, s[12:13]
  v_cndmask_b32 v176, v176, v178, s[14:15]
  s_nop 1
  v_add_f32_dpp v176, v176, v176 quad_perm:[1,0,3,2] row_mask:0xf bank_mask:0xf
  s_nop 1
  v_add_f32_dpp v164, v176, v176 quad_perm:[2,3,0,1] row_mask:0xf bank_mask:0xf
  s_waitcnt vmcnt(32)
  v_mfma_f32_16x16x32_bf16 v[188:191], v[20:23], v[192:195], 0
  s_add_u32 s9, s8, 98304
  buffer_load_dwordx4 v[20:23], v3, s[48:51], s9 offen offset:3072 nt
  v_cndmask_b32 v180, v180, v181, s[12:13]
  v_cndmask_b32 v182, v182, v183, s[12:13]
  v_cndmask_b32 v180, v180, v182, s[14:15]
  s_nop 1
  v_add_f32_dpp v180, v180, v180 quad_perm:[1,0,3,2] row_mask:0xf bank_mask:0xf
  s_nop 1
  v_add_f32_dpp v165, v180, v180 quad_perm:[2,3,0,1] row_mask:0xf bank_mask:0xf
  s_waitcnt vmcnt(32)
  v_mfma_f32_16x16x32_bf16 v[176:179], v[24:27], v[192:195], 0
  s_add_u32 s9, s8, 131072
  buffer_load_dwordx4 v[24:27], v3, s[48:51], s9 offen offset:0 nt
  v_cndmask_b32 v184, v184, v185, s[12:13]
  v_cndmask_b32 v186, v186, v187, s[12:13]
  v_cndmask_b32 v184, v184, v186, s[14:15]
  s_nop 1
  v_add_f32_dpp v184, v184, v184 quad_perm:[1,0,3,2] row_mask:0xf bank_mask:0xf
  s_nop 1
  v_add_f32_dpp v166, v184, v184 quad_perm:[2,3,0,1] row_mask:0xf bank_mask:0xf
  s_waitcnt vmcnt(32)
  v_mfma_f32_16x16x32_bf16 v[180:183], v[28:31], v[192:195], 0
  s_add_u32 s9, s8, 131072
  buffer_load_dwordx4 v[28:31], v3, s[48:51], s9 offen offset:1024 nt
  v_cndmask_b32 v188, v188, v189, s[12:13]
  v_cndmask_b32 v190, v190, v191, s[12:13]
  v_cndmask_b32 v188, v188, v190, s[14:15]
  s_nop 1
  v_add_f32_dpp v188, v188, v188 quad_perm:[1,0,3,2] row_mask:0xf bank_mask:0xf
  s_nop 1
  v_add_f32_dpp v167, v188, v188 quad_perm:[2,3,0,1] row_mask:0xf bank_mask:0xf
  s_waitcnt vmcnt(32)
  v_mfma_f32_16x16x32_bf16 v[184:187], v[32:35], v[192:195], 0
  s_add_u32 s9, s8, 131072
  buffer_load_dwordx4 v[32:35], v3, s[48:51], s9 offen offset:2048 nt
  v_cndmask_b32 v176, v176, v177, s[12:13]
  v_cndmask_b32 v178, v178, v179, s[12:13]
  v_cndmask_b32 v176, v176, v178, s[14:15]
  s_nop 1
  v_add_f32_dpp v176, v176, v176 quad_perm:[1,0,3,2] row_mask:0xf bank_mask:0xf
  s_nop 1
  v_add_f32_dpp v168, v176, v176 quad_perm:[2,3,0,1] row_mask:0xf bank_mask:0xf
  s_waitcnt vmcnt(32)
  v_mfma_f32_16x16x32_bf16 v[188:191], v[36:39], v[192:195], 0
  s_add_u32 s9, s8, 131072
  buffer_load_dwordx4 v[36:39], v3, s[48:51], s9 offen offset:3072 nt
  v_cndmask_b32 v180, v180, v181, s[12:13]
  v_cndmask_b32 v182, v182, v183, s[12:13]
  v_cndmask_b32 v180, v180, v182, s[14:15]
  s_nop 1
  v_add_f32_dpp v180, v180, v180 quad_perm:[1,0,3,2] row_mask:0xf bank_mask:0xf
  s_nop 1
  v_add_f32_dpp v169, v180, v180 quad_perm:[2,3,0,1] row_mask:0xf bank_mask:0xf
  s_waitcnt vmcnt(32)
  v_mfma_f32_16x16x32_bf16 v[176:179], v[40:43], v[192:195], 0
  s_add_u32 s9, s8, 163840
  buffer_load_dwordx4 v[40:43], v3, s[48:51], s9 offen offset:0 nt
  v_cndmask_b32 v184, v184, v185, s[12:13]
  v_cndmask_b32 v186, v186, v187, s[12:13]
  v_cndmask_b32 v184, v184, v186, s[14:15]
  s_nop 1
  v_add_f32_dpp v184, v184, v184 quad_perm:[1,0,3,2] row_mask:0xf bank_mask:0xf
  s_nop 1
  v_add_f32_dpp v170, v184, v184 quad_perm:[2,3,0,1] row_mask:0xf bank_mask:0xf
  s_waitcnt vmcnt(32)
  v_mfma_f32_16x16x32_bf16 v[180:183], v[44:47], v[192:195], 0
  s_add_u32 s9, s8, 163840
  buffer_load_dwordx4 v[44:47], v3, s[48:51], s9 offen offset:1024 nt
  v_cndmask_b32 v188, v188, v189, s[12:13]
  v_cndmask_b32 v190, v190, v191, s[12:13]
  v_cndmask_b32 v188, v188, v190, s[14:15]
  s_nop 1
  v_add_f32_dpp v188, v188, v188 quad_perm:[1,0,3,2] row_mask:0xf bank_mask:0xf
  s_nop 1
  v_add_f32_dpp v171, v188, v188 quad_perm:[2,3,0,1] row_mask:0xf bank_mask:0xf
  s_waitcnt vmcnt(32)
  v_mfma_f32_16x16x32_bf16 v[184:187], v[48:51], v[192:195], 0
  s_add_u32 s9, s8, 163840
  buffer_load_dwordx4 v[48:51], v3, s[48:51], s9 offen offset:2048 nt
  v_cndmask_b32 v176, v176, v177, s[12:13]
  v_cndmask_b32 v178, v178, v179, s[12:13]
  v_cndmask_b32 v176, v176, v178, s[14:15]
  s_nop 1
  v_add_f32_dpp v176, v176, v176 quad_perm:[1,0,3,2] row_mask:0xf bank_mask:0xf
  s_nop 1
  v_add_f32_dpp v172, v176, v176 quad_perm:[2,3,0,1] row_mask:0xf bank_mask:0xf
  s_waitcnt vmcnt(32)
  v_mfma_f32_16x16x32_bf16 v[188:191], v[52:55], v[192:195], 0
  s_add_u32 s9, s8, 163840
  buffer_load_dwordx4 v[52:55], v3, s[48:51], s9 offen offset:3072 nt
  v_cndmask_b32 v180, v180, v181, s[12:13]
  v_cndmask_b32 v182, v182, v183, s[12:13]
  v_cndmask_b32 v180, v180, v182, s[14:15]
  s_nop 1
  v_add_f32_dpp v180, v180, v180 quad_perm:[1,0,3,2] row_mask:0xf bank_mask:0xf
  s_nop 1
  v_add_f32_dpp v173, v180, v180 quad_perm:[2,3,0,1] row_mask:0xf bank_mask:0xf
  v_cndmask_b32 v184, v184, v185, s[12:13]
  v_cndmask_b32 v186, v186, v187, s[12:13]
  v_cndmask_b32 v184, v184, v186, s[14:15]
  s_nop 1
  v_add_f32_dpp v184, v184, v184 quad_perm:[1,0,3,2] row_mask:0xf bank_mask:0xf
  s_nop 1
  v_add_f32_dpp v174, v184, v184 quad_perm:[2,3,0,1] row_mask:0xf bank_mask:0xf
  v_cndmask_b32 v188, v188, v189, s[12:13]
  v_cndmask_b32 v190, v190, v191, s[12:13]
  v_cndmask_b32 v188, v188, v190, s[14:15]
  s_nop 1
  v_add_f32_dpp v188, v188, v188 quad_perm:[1,0,3,2] row_mask:0xf bank_mask:0xf
  s_nop 1
  v_add_f32_dpp v175, v188, v188 quad_perm:[2,3,0,1] row_mask:0xf bank_mask:0xf
  v_mov_b32 v4, 0x3db504f3
  v_cvt_pk_bf16_f32 v112, v112, v113
  v_cvt_pk_bf16_f32 v114, v114, v115
  v_cvt_pk_bf16_f32 v116, v116, v117
  v_cvt_pk_bf16_f32 v118, v118, v119
  v_cvt_pk_bf16_f32 v120, v120, v121
  v_cvt_pk_bf16_f32 v122, v122, v123
  v_cvt_pk_bf16_f32 v124, v124, v125
  v_cvt_pk_bf16_f32 v126, v126, v127
  v_and_b32 v113, 0xffff0000, v112
  v_lshlrev_b32 v112, 16, v112
  v_and_b32 v115, 0xffff0000, v114
  v_lshlrev_b32 v114, 16, v114
  v_and_b32 v117, 0xffff0000, v116
  v_lshlrev_b32 v116, 16, v116
  v_and_b32 v119, 0xffff0000, v118
  v_lshlrev_b32 v118, 16, v118
  v_and_b32 v121, 0xffff0000, v120
  v_lshlrev_b32 v120, 16, v120
  v_and_b32 v123, 0xffff0000, v122
  v_lshlrev_b32 v122, 16, v122
  v_and_b32 v125, 0xffff0000, v124
  v_lshlrev_b32 v124, 16, v124
  v_and_b32 v127, 0xffff0000, v126
  v_lshlrev_b32 v126, 16, v126
  v_mul_f32 v112, v112, v4
  v_mul_f32 v113, v113, v4
  v_mul_f32 v114, v114, v4
  v_mul_f32 v115, v115, v4
  v_mul_f32 v116, v116, v4
  v_mul_f32 v117, v117, v4
  v_mul_f32 v118, v118, v4
  v_mul_f32 v119, v119, v4
  v_mul_f32 v120, v120, v4
  v_mul_f32 v121, v121, v4
  v_mul_f32 v122, v122, v4
  v_mul_f32 v123, v123, v4
  v_mul_f32 v124, v124, v4
  v_mul_f32 v125, v125, v4
  v_mul_f32 v126, v126, v4
  v_mul_f32 v127, v127, v4
  v_cvt_pk_bf16_f32 v112, v112, v113
  v_cvt_pk_bf16_f32 v114, v114, v115
  v_cvt_pk_bf16_f32 v116, v116, v117
  v_cvt_pk_bf16_f32 v118, v118, v119
  v_cvt_pk_bf16_f32 v120, v120, v121
  v_cvt_pk_bf16_f32 v122, v122, v123
  v_cvt_pk_bf16_f32 v124, v124, v125
  v_cvt_pk_bf16_f32 v126, v126, v127
  v_and_b32 v113, 0xffff0000, v112
  v_lshlrev_b32 v112, 16, v112
  v_and_b32 v115, 0xffff0000, v114
  v_lshlrev_b32 v114, 16, v114
  v_and_b32 v117, 0xffff0000, v116
  v_lshlrev_b32 v116, 16, v116
  v_and_b32 v119, 0xffff0000, v118
  v_lshlrev_b32 v118, 16, v118
  v_and_b32 v121, 0xffff0000, v120
  v_lshlrev_b32 v120, 16, v120
  v_and_b32 v123, 0xffff0000, v122
  v_lshlrev_b32 v122, 16, v122
  v_and_b32 v125, 0xffff0000, v124
  v_lshlrev_b32 v124, 16, v124
  v_and_b32 v127, 0xffff0000, v126
  v_lshlrev_b32 v126, 16, v126
  v_cvt_pk_bf16_f32 v128, v128, v129
  v_cvt_pk_bf16_f32 v130, v130, v131
  v_cvt_pk_bf16_f32 v132, v132, v133
  v_cvt_pk_bf16_f32 v134, v134, v135
  v_cvt_pk_bf16_f32 v136, v136, v137
  v_cvt_pk_bf16_f32 v138, v138, v139
  v_cvt_pk_bf16_f32 v140, v140, v141
  v_cvt_pk_bf16_f32 v142, v142, v143
  v_and_b32 v129, 0xffff0000, v128
  v_lshlrev_b32 v128, 16, v128
  v_and_b32 v131, 0xffff0000, v130
  v_lshlrev_b32 v130, 16, v130
  v_and_b32 v133, 0xffff0000, v132
  v_lshlrev_b32 v132, 16, v132
  v_and_b32 v135, 0xffff0000, v134
  v_lshlrev_b32 v134, 16, v134
  v_and_b32 v137, 0xffff0000, v136
  v_lshlrev_b32 v136, 16, v136
  v_and_b32 v139, 0xffff0000, v138
  v_lshlrev_b32 v138, 16, v138
  v_and_b32 v141, 0xffff0000, v140
  v_lshlrev_b32 v140, 16, v140
  v_and_b32 v143, 0xffff0000, v142
  v_lshlrev_b32 v142, 16, v142
  v_mul_f32 v128, v128, v4
  v_mul_f32 v129, v129, v4
  v_mul_f32 v130, v130, v4
  v_mul_f32 v131, v131, v4
  v_mul_f32 v132, v132, v4
  v_mul_f32 v133, v133, v4
  v_mul_f32 v134, v134, v4
  v_mul_f32 v135, v135, v4
  v_mul_f32 v136, v136, v4
  v_mul_f32 v137, v137, v4
  v_mul_f32 v138, v138, v4
  v_mul_f32 v139, v139, v4
  v_mul_f32 v140, v140, v4
  v_mul_f32 v141, v141, v4
  v_mul_f32 v142, v142, v4
  v_mul_f32 v143, v143, v4
  v_cvt_pk_bf16_f32 v128, v128, v129
  v_cvt_pk_bf16_f32 v130, v130, v131
  v_cvt_pk_bf16_f32 v132, v132, v133
  v_cvt_pk_bf16_f32 v134, v134, v135
  v_cvt_pk_bf16_f32 v136, v136, v137
  v_cvt_pk_bf16_f32 v138, v138, v139
  v_cvt_pk_bf16_f32 v140, v140, v141
  v_cvt_pk_bf16_f32 v142, v142, v143
  v_and_b32 v129, 0xffff0000, v128
  v_lshlrev_b32 v128, 16, v128
  v_and_b32 v131, 0xffff0000, v130
  v_lshlrev_b32 v130, 16, v130
  v_and_b32 v133, 0xffff0000, v132
  v_lshlrev_b32 v132, 16, v132
  v_and_b32 v135, 0xffff0000, v134
  v_lshlrev_b32 v134, 16, v134
  v_and_b32 v137, 0xffff0000, v136
  v_lshlrev_b32 v136, 16, v136
  v_and_b32 v139, 0xffff0000, v138
  v_lshlrev_b32 v138, 16, v138
  v_and_b32 v141, 0xffff0000, v140
  v_lshlrev_b32 v140, 16, v140
  v_and_b32 v143, 0xffff0000, v142
  v_lshlrev_b32 v142, 16, v142
  v_cvt_pk_bf16_f32 v144, v144, v145
  v_cvt_pk_bf16_f32 v146, v146, v147
  v_cvt_pk_bf16_f32 v148, v148, v149
  v_cvt_pk_bf16_f32 v150, v150, v151
  v_cvt_pk_bf16_f32 v152, v152, v153
  v_cvt_pk_bf16_f32 v154, v154, v155
  v_cvt_pk_bf16_f32 v156, v156, v157
  v_cvt_pk_bf16_f32 v158, v158, v159
  v_and_b32 v145, 0xffff0000, v144
  v_lshlrev_b32 v144, 16, v144
  v_and_b32 v147, 0xffff0000, v146
  v_lshlrev_b32 v146, 16, v146
  v_and_b32 v149, 0xffff0000, v148
  v_lshlrev_b32 v148, 16, v148
  v_and_b32 v151, 0xffff0000, v150
  v_lshlrev_b32 v150, 16, v150
  v_and_b32 v153, 0xffff0000, v152
  v_lshlrev_b32 v152, 16, v152
  v_and_b32 v155, 0xffff0000, v154
  v_lshlrev_b32 v154, 16, v154
  v_and_b32 v157, 0xffff0000, v156
  v_lshlrev_b32 v156, 16, v156
  v_and_b32 v159, 0xffff0000, v158
  v_lshlrev_b32 v158, 16, v158
  v_mul_f32 v144, v144, v4
  v_mul_f32 v145, v145, v4
  v_mul_f32 v146, v146, v4
  v_mul_f32 v147, v147, v4
  v_mul_f32 v148, v148, v4
  v_mul_f32 v149, v149, v4
  v_mul_f32 v150, v150, v4
  v_mul_f32 v151, v151, v4
  v_mul_f32 v152, v152, v4
  v_mul_f32 v153, v153, v4
  v_mul_f32 v154, v154, v4
  v_mul_f32 v155, v155, v4
  v_mul_f32 v156, v156, v4
  v_mul_f32 v157, v157, v4
  v_mul_f32 v158, v158, v4
  v_mul_f32 v159, v159, v4
  v_cvt_pk_bf16_f32 v144, v144, v145
  v_cvt_pk_bf16_f32 v146, v146, v147
  v_cvt_pk_bf16_f32 v148, v148, v149
  v_cvt_pk_bf16_f32 v150, v150, v151
  v_cvt_pk_bf16_f32 v152, v152, v153
  v_cvt_pk_bf16_f32 v154, v154, v155
  v_cvt_pk_bf16_f32 v156, v156, v157
  v_cvt_pk_bf16_f32 v158, v158, v159
  v_and_b32 v145, 0xffff0000, v144
  v_lshlrev_b32 v144, 16, v144
  v_and_b32 v147, 0xffff0000, v146
  v_lshlrev_b32 v146, 16, v146
  v_and_b32 v149, 0xffff0000, v148
  v_lshlrev_b32 v148, 16, v148
  v_and_b32 v151, 0xffff0000, v150
  v_lshlrev_b32 v150, 16, v150
  v_and_b32 v153, 0xffff0000, v152
  v_lshlrev_b32 v152, 16, v152
  v_and_b32 v155, 0xffff0000, v154
  v_lshlrev_b32 v154, 16, v154
  v_and_b32 v157, 0xffff0000, v156
  v_lshlrev_b32 v156, 16, v156
  v_and_b32 v159, 0xffff0000, v158
  v_lshlrev_b32 v158, 16, v158
  v_cvt_pk_bf16_f32 v160, v160, v161
  v_cvt_pk_bf16_f32 v162, v162, v163
  v_cvt_pk_bf16_f32 v164, v164, v165
  v_cvt_pk_bf16_f32 v166, v166, v167
  v_cvt_pk_bf16_f32 v168, v168, v169
  v_cvt_pk_bf16_f32 v170, v170, v171
  v_cvt_pk_bf16_f32 v172, v172, v173
  v_cvt_pk_bf16_f32 v174, v174, v175
  v_and_b32 v161, 0xffff0000, v160
  v_lshlrev_b32 v160, 16, v160
  v_and_b32 v163, 0xffff0000, v162
  v_lshlrev_b32 v162, 16, v162
  v_and_b32 v165, 0xffff0000, v164
  v_lshlrev_b32 v164, 16, v164
  v_and_b32 v167, 0xffff0000, v166
  v_lshlrev_b32 v166, 16, v166
  v_and_b32 v169, 0xffff0000, v168
  v_lshlrev_b32 v168, 16, v168
  v_and_b32 v171, 0xffff0000, v170
  v_lshlrev_b32 v170, 16, v170
  v_and_b32 v173, 0xffff0000, v172
  v_lshlrev_b32 v172, 16, v172
  v_and_b32 v175, 0xffff0000, v174
  v_lshlrev_b32 v174, 16, v174
  v_mul_f32 v160, v160, v4
  v_mul_f32 v161, v161, v4
  v_mul_f32 v162, v162, v4
  v_mul_f32 v163, v163, v4
  v_mul_f32 v164, v164, v4
  v_mul_f32 v165, v165, v4
  v_mul_f32 v166, v166, v4
  v_mul_f32 v167, v167, v4
  v_mul_f32 v168, v168, v4
  v_mul_f32 v169, v169, v4
  v_mul_f32 v170, v170, v4
  v_mul_f32 v171, v171, v4
  v_mul_f32 v172, v172, v4
  v_mul_f32 v173, v173, v4
  v_mul_f32 v174, v174, v4
  v_mul_f32 v175, v175, v4
  v_cvt_pk_bf16_f32 v160, v160, v161
  v_cvt_pk_bf16_f32 v162, v162, v163
  v_cvt_pk_bf16_f32 v164, v164, v165
  v_cvt_pk_bf16_f32 v166, v166, v167
  v_cvt_pk_bf16_f32 v168, v168, v169
  v_cvt_pk_bf16_f32 v170, v170, v171
  v_cvt_pk_bf16_f32 v172, v172, v173
  v_cvt_pk_bf16_f32 v174, v174, v175
  v_and_b32 v161, 0xffff0000, v160
  v_lshlrev_b32 v160, 16, v160
  v_and_b32 v163, 0xffff0000, v162
  v_lshlrev_b32 v162, 16, v162
  v_and_b32 v165, 0xffff0000, v164
  v_lshlrev_b32 v164, 16, v164
  v_and_b32 v167, 0xffff0000, v166
  v_lshlrev_b32 v166, 16, v166
  v_and_b32 v169, 0xffff0000, v168
  v_lshlrev_b32 v168, 16, v168
  v_and_b32 v171, 0xffff0000, v170
  v_lshlrev_b32 v170, 16, v170
  v_and_b32 v173, 0xffff0000, v172
  v_lshlrev_b32 v172, 16, v172
  v_and_b32 v175, 0xffff0000, v174
  v_lshlrev_b32 v174, 16, v174
  v_max3_f32 v6, v112, v113, v114
  v_max3_f32 v8, v115, v116, v117
  v_max3_f32 v6, v6, v118, v119
  v_max3_f32 v8, v8, v120, v121
  v_max3_f32 v6, v6, v122, v123
  v_max3_f32 v8, v8, v124, v125
  v_max3_f32 v6, v6, v126, v127
  v_max3_f32 v8, v8, v128, v129
  v_max3_f32 v6, v6, v130, v131
  v_max3_f32 v8, v8, v132, v133
  v_max3_f32 v6, v6, v134, v135
  v_max3_f32 v8, v8, v136, v137
  v_max3_f32 v6, v6, v138, v139
  v_max3_f32 v8, v8, v140, v141
  v_max3_f32 v6, v6, v142, v143
  v_max3_f32 v8, v8, v144, v145
  v_max3_f32 v6, v6, v146, v147
  v_max3_f32 v8, v8, v148, v149
  v_max3_f32 v6, v6, v150, v151
  v_max3_f32 v8, v8, v152, v153
  v_max3_f32 v6, v6, v154, v155
  v_max3_f32 v8, v8, v156, v157
  v_max3_f32 v6, v6, v158, v159
  v_max3_f32 v8, v8, v160, v161
  v_max3_f32 v6, v6, v162, v163
  v_max3_f32 v8, v8, v164, v165
  v_max3_f32 v6, v6, v166, v167
  v_max3_f32 v8, v8, v168, v169
  v_max3_f32 v6, v6, v170, v171
  v_max3_f32 v8, v8, v172, v173
  v_max3_f32 v6, v6, v174, v175
  v_max_f32 v6, v6, v8
  v_mov_b32 v8, v6
  s_nop 1
  v_permlane16_swap_b32 v8, v6
  v_max_f32 v6, v6, v8
  v_mov_b32 v8, v6
  s_nop 1
  v_permlane32_swap_b32 v8, v6
  v_max_f32 v6, v6, v8
  v_mul_f32 v9, 0xbfb8aa3b, v6
  v_mov_b32 v4, 0x3fb8aa3b
  v_fma_f32 v112, v112, v4, v9
  v_fma_f32 v113, v113, v4, v9
  v_fma_f32 v114, v114, v4, v9
  v_fma_f32 v115, v115, v4, v9
  v_fma_f32 v116, v116, v4, v9
  v_fma_f32 v117, v117, v4, v9
  v_fma_f32 v118, v118, v4, v9
  v_fma_f32 v119, v119, v4, v9
  v_exp_f32 v112, v112
  v_exp_f32 v113, v113
  v_exp_f32 v114, v114
  v_exp_f32 v115, v115
  v_exp_f32 v116, v116
  v_exp_f32 v117, v117
  v_exp_f32 v118, v118
  v_exp_f32 v119, v119
  v_fma_f32 v120, v120, v4, v9
  v_fma_f32 v121, v121, v4, v9
  v_fma_f32 v122, v122, v4, v9
  v_fma_f32 v123, v123, v4, v9
  v_fma_f32 v124, v124, v4, v9
  v_fma_f32 v125, v125, v4, v9
  v_fma_f32 v126, v126, v4, v9
  v_fma_f32 v127, v127, v4, v9
  v_exp_f32 v120, v120
  v_exp_f32 v121, v121
  v_exp_f32 v122, v122
  v_exp_f32 v123, v123
  v_exp_f32 v124, v124
  v_exp_f32 v125, v125
  v_exp_f32 v126, v126
  v_exp_f32 v127, v127
  v_fma_f32 v128, v128, v4, v9
  v_fma_f32 v129, v129, v4, v9
  v_fma_f32 v130, v130, v4, v9
  v_fma_f32 v131, v131, v4, v9
  v_fma_f32 v132, v132, v4, v9
  v_fma_f32 v133, v133, v4, v9
  v_fma_f32 v134, v134, v4, v9
  v_fma_f32 v135, v135, v4, v9
  v_exp_f32 v128, v128
  v_exp_f32 v129, v129
  v_exp_f32 v130, v130
  v_exp_f32 v131, v131
  v_exp_f32 v132, v132
  v_exp_f32 v133, v133
  v_exp_f32 v134, v134
  v_exp_f32 v135, v135
  v_fma_f32 v136, v136, v4, v9
  v_fma_f32 v137, v137, v4, v9
  v_fma_f32 v138, v138, v4, v9
  v_fma_f32 v139, v139, v4, v9
  v_fma_f32 v140, v140, v4, v9
  v_fma_f32 v141, v141, v4, v9
  v_fma_f32 v142, v142, v4, v9
  v_fma_f32 v143, v143, v4, v9
  v_exp_f32 v136, v136
  v_exp_f32 v137, v137
  v_exp_f32 v138, v138
  v_exp_f32 v139, v139
  v_exp_f32 v140, v140
  v_exp_f32 v141, v141
  v_exp_f32 v142, v142
  v_exp_f32 v143, v143
  v_fma_f32 v144, v144, v4, v9
  v_fma_f32 v145, v145, v4, v9
  v_fma_f32 v146, v146, v4, v9
  v_fma_f32 v147, v147, v4, v9
  v_fma_f32 v148, v148, v4, v9
  v_fma_f32 v149, v149, v4, v9
  v_fma_f32 v150, v150, v4, v9
  v_fma_f32 v151, v151, v4, v9
  v_exp_f32 v144, v144
  v_exp_f32 v145, v145
  v_exp_f32 v146, v146
  v_exp_f32 v147, v147
  v_exp_f32 v148, v148
  v_exp_f32 v149, v149
  v_exp_f32 v150, v150
  v_exp_f32 v151, v151
  v_fma_f32 v152, v152, v4, v9
  v_fma_f32 v153, v153, v4, v9
  v_fma_f32 v154, v154, v4, v9
  v_fma_f32 v155, v155, v4, v9
  v_fma_f32 v156, v156, v4, v9
  v_fma_f32 v157, v157, v4, v9
  v_fma_f32 v158, v158, v4, v9
  v_fma_f32 v159, v159, v4, v9
  v_exp_f32 v152, v152
  v_exp_f32 v153, v153
  v_exp_f32 v154, v154
  v_exp_f32 v155, v155
  v_exp_f32 v156, v156
  v_exp_f32 v157, v157
  v_exp_f32 v158, v158
  v_exp_f32 v159, v159
  v_fma_f32 v160, v160, v4, v9
  v_fma_f32 v161, v161, v4, v9
  v_fma_f32 v162, v162, v4, v9
  v_fma_f32 v163, v163, v4, v9
  v_fma_f32 v164, v164, v4, v9
  v_fma_f32 v165, v165, v4, v9
  v_fma_f32 v166, v166, v4, v9
  v_fma_f32 v167, v167, v4, v9
  v_exp_f32 v160, v160
  v_exp_f32 v161, v161
  v_exp_f32 v162, v162
  v_exp_f32 v163, v163
  v_exp_f32 v164, v164
  v_exp_f32 v165, v165
  v_exp_f32 v166, v166
  v_exp_f32 v167, v167
  v_fma_f32 v168, v168, v4, v9
  v_fma_f32 v169, v169, v4, v9
  v_fma_f32 v170, v170, v4, v9
  v_fma_f32 v171, v171, v4, v9
  v_fma_f32 v172, v172, v4, v9
  v_fma_f32 v173, v173, v4, v9
  v_fma_f32 v174, v174, v4, v9
  v_fma_f32 v175, v175, v4, v9
  v_exp_f32 v168, v168
  v_exp_f32 v169, v169
  v_exp_f32 v170, v170
  v_exp_f32 v171, v171
  v_exp_f32 v172, v172
  v_exp_f32 v173, v173
  v_exp_f32 v174, v174
  v_exp_f32 v175, v175
  v_add_f32 v7, v112, v113
  v_add_f32 v8, v114, v115
  v_add_f32 v7, v7, v116
  v_add_f32 v8, v8, v117
  v_add_f32 v7, v7, v118
  v_add_f32 v8, v8, v119
  v_add_f32 v7, v7, v120
  v_add_f32 v8, v8, v121
  v_add_f32 v7, v7, v122
  v_add_f32 v8, v8, v123
  v_add_f32 v7, v7, v124
  v_add_f32 v8, v8, v125
  v_add_f32 v7, v7, v126
  v_add_f32 v8, v8, v127
  v_add_f32 v7, v7, v128
  v_add_f32 v8, v8, v129
  v_add_f32 v7, v7, v130
  v_add_f32 v8, v8, v131
  v_add_f32 v7, v7, v132
  v_add_f32 v8, v8, v133
  v_add_f32 v7, v7, v134
  v_add_f32 v8, v8, v135
  v_add_f32 v7, v7, v136
  v_add_f32 v8, v8, v137
  v_add_f32 v7, v7, v138
  v_add_f32 v8, v8, v139
  v_add_f32 v7, v7, v140
  v_add_f32 v8, v8, v141
  v_add_f32 v7, v7, v142
  v_add_f32 v8, v8, v143
  v_add_f32 v7, v7, v144
  v_add_f32 v8, v8, v145
  v_add_f32 v7, v7, v146
  v_add_f32 v8, v8, v147
  v_add_f32 v7, v7, v148
  v_add_f32 v8, v8, v149
  v_add_f32 v7, v7, v150
  v_add_f32 v8, v8, v151
  v_add_f32 v7, v7, v152
  v_add_f32 v8, v8, v153
  v_add_f32 v7, v7, v154
  v_add_f32 v8, v8, v155
  v_add_f32 v7, v7, v156
  v_add_f32 v8, v8, v157
  v_add_f32 v7, v7, v158
  v_add_f32 v8, v8, v159
  v_add_f32 v7, v7, v160
  v_add_f32 v8, v8, v161
  v_add_f32 v7, v7, v162
  v_add_f32 v8, v8, v163
  v_add_f32 v7, v7, v164
  v_add_f32 v8, v8, v165
  v_add_f32 v7, v7, v166
  v_add_f32 v8, v8, v167
  v_add_f32 v7, v7, v168
  v_add_f32 v8, v8, v169
  v_add_f32 v7, v7, v170
  v_add_f32 v8, v8, v171
  v_add_f32 v7, v7, v172
  v_add_f32 v8, v8, v173
  v_add_f32 v7, v7, v174
  v_add_f32 v8, v8, v175
  v_add_f32 v7, v7, v8
  v_mov_b32 v8, v7
  s_nop 1
  v_permlane16_swap_b32 v8, v7
  v_add_f32 v7, v7, v8
  v_mov_b32 v8, v7
  s_nop 1
  v_permlane32_swap_b32 v8, v7
  v_add_f32 v7, v7, v8
  v_cvt_pk_bf16_f32 v112, v112, v113
  v_cvt_pk_bf16_f32 v113, v114, v115
  v_cvt_pk_bf16_f32 v114, v116, v117
  v_cvt_pk_bf16_f32 v115, v118, v119
  v_cvt_pk_bf16_f32 v120, v120, v121
  v_cvt_pk_bf16_f32 v121, v122, v123
  v_cvt_pk_bf16_f32 v122, v124, v125
  v_cvt_pk_bf16_f32 v123, v126, v127
  v_cvt_pk_bf16_f32 v128, v128, v129
  v_cvt_pk_bf16_f32 v129, v130, v131
  v_cvt_pk_bf16_f32 v130, v132, v133
  v_cvt_pk_bf16_f32 v131, v134, v135
  v_cvt_pk_bf16_f32 v136, v136, v137
  v_cvt_pk_bf16_f32 v137, v138, v139
  v_cvt_pk_bf16_f32 v138, v140, v141
  v_cvt_pk_bf16_f32 v139, v142, v143
  v_cvt_pk_bf16_f32 v144, v144, v145
  v_cvt_pk_bf16_f32 v145, v146, v147
  v_cvt_pk_bf16_f32 v146, v148, v149
  v_cvt_pk_bf16_f32 v147, v150, v151
  v_cvt_pk_bf16_f32 v152, v152, v153
  v_cvt_pk_bf16_f32 v153, v154, v155
  v_cvt_pk_bf16_f32 v154, v156, v157
  v_cvt_pk_bf16_f32 v155, v158, v159
  v_cvt_pk_bf16_f32 v160, v160, v161
  v_cvt_pk_bf16_f32 v161, v162, v163
  v_cvt_pk_bf16_f32 v162, v164, v165
  v_cvt_pk_bf16_f32 v163, v166, v167
  v_cvt_pk_bf16_f32 v168, v168, v169
  v_cvt_pk_bf16_f32 v169, v170, v171
  v_cvt_pk_bf16_f32 v170, v172, v173
  v_cvt_pk_bf16_f32 v171, v174, v175
  v_bfe_u32 v4, v1, 2, 1
  s_lshl_b32 s9, s3, 4
  s_add_u32 s9, s9, 95488
  v_lshl_add_u32 v4, v4, 3, s9
  ds_write_b64 v4, v[6:7]
  s_lshl_b32 s28, s2, 11
  s_add_u32 s28, s28, 524288
  s_and_b32 s29, s2, 0xfc
  s_lshl_b32 s29, s29, 11
  s_add_u32 s29, s29, 524288
  s_add_u32 s27, s29, 4096
  s_lshl_b32 s30, s6, 8
  s_add_u32 s30, s30, s29
  s_mul_i32 s31, s2, 2304
  s_add_u32 s31, s31, 1048576
  s_bfe_u32 s9, s3, 0x10001
  s_lshl_b32 s9, s9, 3
  v_mov_b32 v11, s9
  s_waitcnt lgkmcnt(0)
  s_barrier
  s_waitcnt vmcnt(25)
  v_perm_b32 v228, v60, v56, s10
  v_perm_b32 v229, v68, v64, s10
  v_perm_b32 v230, v76, v72, s10
  v_perm_b32 v231, v84, v80, s10
  v_perm_b32 v232, v60, v56, s11
  v_perm_b32 v233, v68, v64, s11
  v_perm_b32 v234, v76, v72, s11
  v_perm_b32 v235, v84, v80, s11
  v_mfma_f32_16x16x32_bf16 v[196:199], v[112:115], v[228:231], 0
  s_nop 0
  v_mfma_f32_16x16x32_bf16 v[200:203], v[112:115], v[232:235], 0
  v_perm_b32 v236, v61, v57, s10
  v_perm_b32 v237, v69, v65, s10
  v_perm_b32 v238, v77, v73, s10
  v_perm_b32 v239, v85, v81, s10
  v_perm_b32 v240, v61, v57, s11
  v_perm_b32 v241, v69, v65, s11
  v_perm_b32 v242, v77, v73, s11
  v_perm_b32 v243, v85, v81, s11
  v_mfma_f32_16x16x32_bf16 v[204:207], v[112:115], v[236:239], 0
  s_nop 0
  v_mfma_f32_16x16x32_bf16 v[208:211], v[112:115], v[240:243], 0
  v_perm_b32 v228, v62, v58, s10
  v_perm_b32 v229, v70, v66, s10
  v_perm_b32 v230, v78, v74, s10
  v_perm_b32 v231, v86, v82, s10
  v_perm_b32 v232, v62, v58, s11
  v_perm_b32 v233, v70, v66, s11
  v_perm_b32 v234, v78, v74, s11
  v_perm_b32 v235, v86, v82, s11
  v_mfma_f32_16x16x32_bf16 v[212:215], v[112:115], v[228:231], 0
  s_nop 0
  v_mfma_f32_16x16x32_bf16 v[216:219], v[112:115], v[232:235], 0
  v_perm_b32 v236, v63, v59, s10
  v_perm_b32 v237, v71, v67, s10
  v_perm_b32 v238, v79, v75, s10
  v_perm_b32 v239, v87, v83, s10
  v_perm_b32 v240, v63, v59, s11
  v_perm_b32 v241, v71, v67, s11
  v_perm_b32 v242, v79, v75, s11
  v_perm_b32 v243, v87, v83, s11
  s_add_u32 s9, s8, 196608
  buffer_load_dwordx4 v[56:59], v3, s[48:51], s9 offen offset:0 nt
  s_add_u32 s9, s8, 196608
  buffer_load_dwordx4 v[60:63], v3, s[48:51], s9 offen offset:1024 nt
  s_add_u32 s9, s8, 196608
  buffer_load_dwordx4 v[64:67], v3, s[48:51], s9 offen offset:2048 nt
  s_add_u32 s9, s8, 196608
  buffer_load_dwordx4 v[68:71], v3, s[48:51], s9 offen offset:3072 nt
  s_add_u32 s9, s8, 229376
  buffer_load_dwordx4 v[72:75], v3, s[48:51], s9 offen offset:0 nt
  s_add_u32 s9, s8, 229376
  buffer_load_dwordx4 v[76:79], v3, s[48:51], s9 offen offset:1024 nt
  s_add_u32 s9, s8, 229376
  buffer_load_dwordx4 v[80:83], v3, s[48:51], s9 offen offset:2048 nt
  s_add_u32 s9, s8, 229376
  buffer_load_dwordx4 v[84:87], v3, s[48:51], s9 offen offset:3072 nt
  v_mfma_f32_16x16x32_bf16 v[220:223], v[112:115], v[236:239], 0
  v_mfma_f32_16x16x32_bf16 v[224:227], v[112:115], v[240:243], 0
  v_add_u32 v4, 95488, v11
  ds_read_b64 v[176:177], v4 offset:0
  ds_read_b64 v[178:179], v4 offset:16
  ds_read_b64 v[180:181], v4 offset:32
  ds_read_b64 v[182:183], v4 offset:48
  ds_read_b64 v[184:185], v4 offset:64
  ds_read_b64 v[186:187], v4 offset:80
  ds_read_b64 v[188:189], v4 offset:96
  ds_read_b64 v[190:191], v4 offset:112
  s_waitcnt lgkmcnt(0)
  v_max3_f32 v6, v176, v178, v180
  v_max3_f32 v6, v6, v182, v184
  v_max3_f32 v6, v6, v186, v188
  v_max_f32 v6, v6, v190
  v_sub_f32 v244, v176, v6
  v_sub_f32 v245, v178, v6
  v_sub_f32 v246, v180, v6
  v_sub_f32 v247, v182, v6
  v_sub_f32 v248, v184, v6
  v_sub_f32 v249, v186, v6
  v_sub_f32 v250, v188, v6
  v_sub_f32 v251, v190, v6
  v_mul_f32 v244, 0x3fb8aa3b, v244
  v_mul_f32 v245, 0x3fb8aa3b, v245
  v_mul_f32 v246, 0x3fb8aa3b, v246
  v_mul_f32 v247, 0x3fb8aa3b, v247
  v_mul_f32 v248, 0x3fb8aa3b, v248
  v_mul_f32 v249, 0x3fb8aa3b, v249
  v_mul_f32 v250, 0x3fb8aa3b, v250
  v_mul_f32 v251, 0x3fb8aa3b, v251
  v_exp_f32 v244, v244
  v_exp_f32 v245, v245
  v_exp_f32 v246, v246
  v_exp_f32 v247, v247
  v_exp_f32 v248, v248
  v_exp_f32 v249, v249
  v_exp_f32 v250, v250
  v_exp_f32 v251, v251
  v_mul_f32 v7, v244, v177
  v_fmac_f32 v7, v245, v179
  v_fmac_f32 v7, v246, v181
  v_fmac_f32 v7, v247, v183
  v_fmac_f32 v7, v248, v185
  v_fmac_f32 v7, v249, v187
  v_fmac_f32 v7, v250, v189
  v_fmac_f32 v7, v251, v191
  s_and_b32 s9, s3, 5
  s_cselect_b64 exec, 0, 1
  buffer_store_dwordx2 v[6:7], v11, s[88:91], s28 offen offset:1024 sc0 sc1
  s_mov_b64 exec, -1
  s_barrier
  s_waitcnt vmcnt(17)
  v_perm_b32 v228, v92, v88, s10
  v_perm_b32 v229, v100, v96, s10
  v_perm_b32 v230, v108, v104, s10
  v_perm_b32 v231, v20, v16, s10
  v_perm_b32 v232, v92, v88, s11
  v_perm_b32 v233, v100, v96, s11
  v_perm_b32 v234, v108, v104, s11
  v_perm_b32 v235, v20, v16, s11
  v_mfma_f32_16x16x32_bf16 v[196:199], v[120:123], v[228:231], v[196:199]
  s_nop 0
  v_mfma_f32_16x16x32_bf16 v[200:203], v[120:123], v[232:235], v[200:203]
  v_perm_b32 v236, v93, v89, s10
  v_perm_b32 v237, v101, v97, s10
  v_perm_b32 v238, v109, v105, s10
  v_perm_b32 v239, v21, v17, s10
  v_perm_b32 v240, v93, v89, s11
  v_perm_b32 v241, v101, v97, s11
  v_perm_b32 v242, v109, v105, s11
  v_perm_b32 v243, v21, v17, s11
  v_mfma_f32_16x16x32_bf16 v[204:207], v[120:123], v[236:239], v[204:207]
  s_nop 0
  v_mfma_f32_16x16x32_bf16 v[208:211], v[120:123], v[240:243], v[208:211]
  v_perm_b32 v228, v94, v90, s10
  v_perm_b32 v229, v102, v98, s10
  v_perm_b32 v230, v110, v106, s10
  v_perm_b32 v231, v22, v18, s10
  v_perm_b32 v232, v94, v90, s11
  v_perm_b32 v233, v102, v98, s11
  v_perm_b32 v234, v110, v106, s11
  v_perm_b32 v235, v22, v18, s11
  v_mfma_f32_16x16x32_bf16 v[212:215], v[120:123], v[228:231], v[212:215]
  s_nop 0
  v_mfma_f32_16x16x32_bf16 v[216:219], v[120:123], v[232:235], v[216:219]
  v_perm_b32 v236, v95, v91, s10
  v_perm_b32 v237, v103, v99, s10
  v_perm_b32 v238, v111, v107, s10
  v_perm_b32 v239, v23, v19, s10
  v_perm_b32 v240, v95, v91, s11
  v_perm_b32 v241, v103, v99, s11
  v_perm_b32 v242, v111, v107, s11
  v_perm_b32 v243, v23, v19, s11
  s_add_u32 s9, s8, 262144
  buffer_load_dwordx4 v[88:91], v3, s[48:51], s9 offen offset:0 nt
  s_add_u32 s9, s8, 262144
  buffer_load_dwordx4 v[92:95], v3, s[48:51], s9 offen offset:1024 nt
  s_add_u32 s9, s8, 262144
  buffer_load_dwordx4 v[96:99], v3, s[48:51], s9 offen offset:2048 nt
  s_add_u32 s9, s8, 262144
  buffer_load_dwordx4 v[100:103], v3, s[48:51], s9 offen offset:3072 nt
  s_add_u32 s9, s8, 294912
  buffer_load_dwordx4 v[104:107], v3, s[48:51], s9 offen offset:0 nt
  s_add_u32 s9, s8, 294912
  buffer_load_dwordx4 v[108:111], v3, s[48:51], s9 offen offset:1024 nt
  s_add_u32 s9, s8, 294912
  buffer_load_dwordx4 v[16:19], v3, s[48:51], s9 offen offset:2048 nt
  s_add_u32 s9, s8, 294912
  buffer_load_dwordx4 v[20:23], v3, s[48:51], s9 offen offset:3072 nt
  v_mfma_f32_16x16x32_bf16 v[220:223], v[120:123], v[236:239], v[220:223]
  v_mfma_f32_16x16x32_bf16 v[224:227], v[120:123], v[240:243], v[224:227]
  s_cmp_lg_u32 s3, 4
  s_cbranch_scc1 L_gate_done
  v_and_b32 v4, 15, v1
  v_mov_b32 v5, 95616
  v_lshl_add_u32 v4, v4, 2, v5
  ds_read_b32 v244, v4 offset:0
  ds_read_b32 v245, v4 offset:64
  ds_read_b32 v246, v4 offset:128
  ds_read_b32 v247, v4 offset:192
  ds_read_b32 v248, v4 offset:256
  ds_read_b32 v249, v4 offset:320
  ds_read_b32 v250, v4 offset:384
  ds_read_b32 v251, v4 offset:448
  s_waitcnt lgkmcnt(0)
  v_add_f32 v244, v244, v245
  v_add_f32 v244, v244, v246
  v_add_f32 v244, v244, v247
  v_add_f32 v244, v244, v248
  v_add_f32 v244, v244, v249
  v_add_f32 v244, v244, v250
  v_add_f32 v244, v244, v251
  v_cvt_pk_bf16_f32 v244, v244, v244
  v_lshlrev_b32 v244, 16, v244
  v_lshlrev_b32 v245, 16, v14
  v_add_f32 v244, v244, v245
  v_cvt_pk_bf16_f32 v244, v244, v244
  v_lshlrev_b32 v244, 16, v244
  v_mul_f32 v245, 0xbfb8aa3b, v244
  v_exp_f32 v245, v245
  s_nop 0
  v_add_f32 v245, 1.0, v245
  v_rcp_f32 v246, v245
  s_nop 0
  v_mul_f32 v247, v244, v246
  v_fma_f32 v248, -v247, v245, v244
  v_fma_f32 v244, v248, v246, v247
  v_cvt_pk_bf16_f32 v244, v244, v244
  v_lshlrev_b32 v244, 16, v244
  s_mul_i32 s9, s2, 36
  s_add_u32 s9, s9, 1703936
  v_lshlrev_b32 v4, 2, v1
  s_mov_b64 exec, 0x1ff
  buffer_store_dword v244, v4, s[88:91], s9 offen sc0 sc1
  s_mov_b64 exec, -1
L_gate_done:
  s_nop 7
  s_barrier
  s_waitcnt vmcnt(17)
  s_cmp_lt_u32 s3, 4
  s_cselect_b64 exec, -1, 0
  buffer_load_dwordx2 v[244:245], v11, s[88:91], s29 offen offset:1024 sc0 sc1
  buffer_load_dwordx2 v[246:247], v11, s[88:91], s29 offen offset:3072 sc0 sc1
  buffer_load_dwordx2 v[248:249], v11, s[88:91], s27 offen offset:1024 sc0 sc1
  buffer_load_dwordx2 v[250:251], v11, s[88:91], s27 offen offset:3072 sc0 sc1
  s_mov_b64 exec, -1
  v_perm_b32 v228, v28, v24, s10
  v_perm_b32 v229, v36, v32, s10
  v_perm_b32 v230, v44, v40, s10
  v_perm_b32 v231, v52, v48, s10
  v_perm_b32 v232, v28, v24, s11
  v_perm_b32 v233, v36, v32, s11
  v_perm_b32 v234, v44, v40, s11
  v_perm_b32 v235, v52, v48, s11
  v_mfma_f32_16x16x32_bf16 v[196:199], v[128:131], v[228:231], v[196:199]
  s_nop 0
  v_mfma_f32_16x16x32_bf16 v[200:203], v[128:131], v[232:235], v[200:203]
  v_perm_b32 v236, v29, v25, s10
  v_perm_b32 v237, v37, v33, s10
  v_perm_b32 v238, v45, v41, s10
  v_perm_b32 v239, v53, v49, s10
  v_perm_b32 v240, v29, v25, s11
  v_perm_b32 v241, v37, v33, s11
  v_perm_b32 v242, v45, v41, s11
  v_perm_b32 v243, v53, v49, s11
  v_mfma_f32_16x16x32_bf16 v[204:207], v[128:131], v[236:239], v[204:207]
  s_nop 0
  v_mfma_f32_16x16x32_bf16 v[208:211], v[128:131], v[240:243], v[208:211]
  v_perm_b32 v228, v30, v26, s10
  v_perm_b32 v229, v38, v34, s10
  v_perm_b32 v230, v46, v42, s10
  v_perm_b32 v231, v54, v50, s10
  v_perm_b32 v232, v30, v26, s11
  v_perm_b32 v233, v38, v34, s11
  v_perm_b32 v234, v46, v42, s11
  v_perm_b32 v235, v54, v50, s11
  v_mfma_f32_16x16x32_bf16 v[212:215], v[128:131], v[228:231], v[212:215]
  s_nop 0
  v_mfma_f32_16x16x32_bf16 v[216:219], v[128:131], v[232:235], v[216:219]
  v_perm_b32 v236, v31, v27, s10
  v_perm_b32 v237, v39, v35, s10
  v_perm_b32 v238, v47, v43, s10
  v_perm_b32 v239, v55, v51, s10
  v_perm_b32 v240, v31, v27, s11
  v_perm_b32 v241, v39, v35, s11
  v_perm_b32 v242, v47, v43, s11
  v_perm_b32 v243, v55, v51, s11
  s_add_u32 s9, s8, 327680
  buffer_load_dwordx4 v[24:27], v3, s[48:51], s9 offen offset:0 nt
  s_add_u32 s9, s8, 327680
  buffer_load_dwordx4 v[28:31], v3, s[48:51], s9 offen offset:1024 nt
  s_add_u32 s9, s8, 327680
  buffer_load_dwordx4 v[32:35], v3, s[48:51], s9 offen offset:2048 nt
  s_add_u32 s9, s8, 327680
  buffer_load_dwordx4 v[36:39], v3, s[48:51], s9 offen offset:3072 nt
  s_add_u32 s9, s8, 360448
  buffer_load_dwordx4 v[40:43], v3, s[48:51], s9 offen offset:0 nt
  s_add_u32 s9, s8, 360448
  buffer_load_dwordx4 v[44:47], v3, s[48:51], s9 offen offset:1024 nt
  s_add_u32 s9, s8, 360448
  buffer_load_dwordx4 v[48:51], v3, s[48:51], s9 offen offset:2048 nt
  s_add_u32 s9, s8, 360448
  buffer_load_dwordx4 v[52:55], v3, s[48:51], s9 offen offset:3072 nt
  v_mfma_f32_16x16x32_bf16 v[220:223], v[128:131], v[236:239], v[220:223]
  v_mfma_f32_16x16x32_bf16 v[224:227], v[128:131], v[240:243], v[224:227]
  v_lshrrev_b32 v4, 4, v1
  v_bfe_u32 v5, v1, 2, 2
  v_lshl_add_u32 v5, v5, 3, v4
  v_mul_u32_u24 v5, 1152, v5
  v_and_b32 v6, 3, v1
  v_lshl_add_u32 v5, v6, 3, v5
  s_lshl_b32 s9, s3, 5
  v_add_u32 v5, s9, v5
  v_lshlrev_b32 v10, 11, v6
  v_lshl_add_u32 v10, v4, 5, v10
  v_bfe_u32 v6, v1, 2, 1
  v_lshl_add_u32 v10, v6, 7, v10
  v_mov_b32 v12, 96128
  v_lshl_add_u32 v12, v4, 4, v12
  v_lshl_add_u32 v195, v6, 6, v12
  ds_read_b64_tr_b16 v[116:117], v5 offset:0
  ds_read_b64_tr_b16 v[118:119], v5 offset:36864
  ds_read_b64_tr_b16 v[124:125], v5 offset:4608
  ds_read_b64_tr_b16 v[126:127], v5 offset:41472
  ds_read_b64_tr_b16 v[132:133], v5 offset:256
  ds_read_b64_tr_b16 v[134:135], v5 offset:37120
  ds_read_b64_tr_b16 v[140:141], v5 offset:4864
  ds_read_b64_tr_b16 v[142:143], v5 offset:41728
  ds_read_b64_tr_b16 v[148:149], v5 offset:512
  ds_read_b64_tr_b16 v[150:151], v5 offset:37376
  ds_read_b64_tr_b16 v[156:157], v5 offset:5120
  ds_read_b64_tr_b16 v[158:159], v5 offset:41984
  ds_read_b64_tr_b16 v[164:165], v5 offset:768
  ds_read_b64_tr_b16 v[166:167], v5 offset:37632
  ds_read_b64_tr_b16 v[172:173], v5 offset:5376
  ds_read_b64_tr_b16 v[174:175], v5 offset:42240
  s_cmp_ge_u32 s3, 4
  s_cbranch_scc1 L_bfrag_done
  ds_read_b64_tr_b16 v[112:113], v5 offset:1024
  ds_read_b64_tr_b16 v[114:115], v5 offset:37888
  ds_read_b64_tr_b16 v[120:121], v5 offset:5632
  ds_read_b64_tr_b16 v[122:123], v5 offset:42496
L_bfrag_done:
  s_nop 7
  v_bfe_u32 v6, v1, 3, 2
  v_mul_u32_u24 v6, 288, v6
  v_and_b32 v7, 7, v1
  v_lshl_add_u32 v6, v7, 2, v6
  s_mul_i32 s9, s3, 1152
  s_add_u32 s9, s9, 86272
  v_add_u32 v6, s9, v6
  v_and_b32 v7, 15, v1
  v_lshlrev_b32 v7, 2, v7
  s_lshl_b32 s9, s3, 6
  v_add_u32 v7, s9, v7
  v_lshlrev_b32 v9, 2, v0
  s_mul_i32 s9, s3, 288
  s_add_u32 s9, s9, 86272
  v_lshl_add_u32 v8, v1, 2, s9
  s_waitcnt lgkmcnt(0)
  s_barrier
  s_waitcnt vmcnt(21)
  v_perm_b32 v228, v60, v56, s10
  v_perm_b32 v229, v68, v64, s10
  v_perm_b32 v230, v76, v72, s10
  v_perm_b32 v231, v84, v80, s10
  v_perm_b32 v232, v60, v56, s11
  v_perm_b32 v233, v68, v64, s11
  v_perm_b32 v234, v76, v72, s11
  v_perm_b32 v235, v84, v80, s11
  v_mfma_f32_16x16x32_bf16 v[196:199], v[136:139], v[228:231], v[196:199]
  s_nop 0
  v_mfma_f32_16x16x32_bf16 v[200:203], v[136:139], v[232:235], v[200:203]
  v_perm_b32 v236, v61, v57, s10
  v_perm_b32 v237, v69, v65, s10
  v_perm_b32 v238, v77, v73, s10
  v_perm_b32 v239, v85, v81, s10
  v_perm_b32 v240, v61, v57, s11
  v_perm_b32 v241, v69, v65, s11
  v_perm_b32 v242, v77, v73, s11
  v_perm_b32 v243, v85, v81, s11
  v_mfma_f32_16x16x32_bf16 v[204:207], v[136:139], v[236:239], v[204:207]
  s_nop 0
  v_mfma_f32_16x16x32_bf16 v[208:211], v[136:139], v[240:243], v[208:211]
  v_perm_b32 v228, v62, v58, s10
  v_perm_b32 v229, v70, v66, s10
  v_perm_b32 v230, v78, v74, s10
  v_perm_b32 v231, v86, v82, s10
  v_perm_b32 v232, v62, v58, s11
  v_perm_b32 v233, v70, v66, s11
  v_perm_b32 v234, v78, v74, s11
  v_perm_b32 v235, v86, v82, s11
  v_mfma_f32_16x16x32_bf16 v[212:215], v[136:139], v[228:231], v[212:215]
  s_nop 0
  v_mfma_f32_16x16x32_bf16 v[216:219], v[136:139], v[232:235], v[216:219]
  v_perm_b32 v236, v63, v59, s10
  v_perm_b32 v237, v71, v67, s10
  v_perm_b32 v238, v79, v75, s10
  v_perm_b32 v239, v87, v83, s10
  v_perm_b32 v240, v63, v59, s11
  v_perm_b32 v241, v71, v67, s11
  v_perm_b32 v242, v79, v75, s11
  v_perm_b32 v243, v87, v83, s11
  s_add_u32 s9, s8, 393216
  buffer_load_dwordx4 v[56:59], v3, s[48:51], s9 offen offset:0 nt
  s_add_u32 s9, s8, 393216
  buffer_load_dwordx4 v[60:63], v3, s[48:51], s9 offen offset:1024 nt
  s_add_u32 s9, s8, 393216
  buffer_load_dwordx4 v[64:67], v3, s[48:51], s9 offen offset:2048 nt
  s_add_u32 s9, s8, 393216
  buffer_load_dwordx4 v[68:71], v3, s[48:51], s9 offen offset:3072 nt
  s_add_u32 s9, s8, 425984
  buffer_load_dwordx4 v[72:75], v3, s[48:51], s9 offen offset:0 nt
  s_add_u32 s9, s8, 425984
  buffer_load_dwordx4 v[76:79], v3, s[48:51], s9 offen offset:1024 nt
  s_add_u32 s9, s8, 425984
  buffer_load_dwordx4 v[80:83], v3, s[48:51], s9 offen offset:2048 nt
  s_add_u32 s9, s8, 425984
  buffer_load_dwordx4 v[84:87], v3, s[48:51], s9 offen offset:3072 nt
  v_mfma_f32_16x16x32_bf16 v[220:223], v[136:139], v[236:239], v[220:223]
  v_mfma_f32_16x16x32_bf16 v[224:227], v[136:139], v[240:243], v[224:227]
  s_barrier
  s_waitcnt vmcnt(20)
  v_perm_b32 v228, v92, v88, s10
  v_perm_b32 v229, v100, v96, s10
  v_perm_b32 v230, v108, v104, s10
  v_perm_b32 v231, v20, v16, s10
  v_perm_b32 v232, v92, v88, s11
  v_perm_b32 v233, v100, v96, s11
  v_perm_b32 v234, v108, v104, s11
  v_perm_b32 v235, v20, v16, s11
  v_mfma_f32_16x16x32_bf16 v[196:199], v[144:147], v[228:231], v[196:199]
  s_nop 0
  v_mfma_f32_16x16x32_bf16 v[200:203], v[144:147], v[232:235], v[200:203]
  v_perm_b32 v236, v93, v89, s10
  v_perm_b32 v237, v101, v97, s10
  v_perm_b32 v238, v109, v105, s10
  v_perm_b32 v239, v21, v17, s10
  v_perm_b32 v240, v93, v89, s11
  v_perm_b32 v241, v101, v97, s11
  v_perm_b32 v242, v109, v105, s11
  v_perm_b32 v243, v21, v17, s11
  v_mfma_f32_16x16x32_bf16 v[204:207], v[144:147], v[236:239], v[204:207]
  s_nop 0
  v_mfma_f32_16x16x32_bf16 v[208:211], v[144:147], v[240:243], v[208:211]
  v_perm_b32 v228, v94, v90, s10
  v_perm_b32 v229, v102, v98, s10
  v_perm_b32 v230, v110, v106, s10
  v_perm_b32 v231, v22, v18, s10
  v_perm_b32 v232, v94, v90, s11
  v_perm_b32 v233, v102, v98, s11
  v_perm_b32 v234, v110, v106, s11
  v_perm_b32 v235, v22, v18, s11
  v_mfma_f32_16x16x32_bf16 v[212:215], v[144:147], v[228:231], v[212:215]
  s_nop 0
  v_mfma_f32_16x16x32_bf16 v[216:219], v[144:147], v[232:235], v[216:219]
  v_perm_b32 v236, v95, v91, s10
  v_perm_b32 v237, v103, v99, s10
  v_perm_b32 v238, v111, v107, s10
  v_perm_b32 v239, v23, v19, s10
  v_perm_b32 v240, v95, v91, s11
  v_perm_b32 v241, v103, v99, s11
  v_perm_b32 v242, v111, v107, s11
  v_perm_b32 v243, v23, v19, s11
  s_add_u32 s9, s8, 458752
  buffer_load_dwordx4 v[88:91], v3, s[48:51], s9 offen offset:0 nt
  s_add_u32 s9, s8, 458752
  buffer_load_dwordx4 v[92:95], v3, s[48:51], s9 offen offset:1024 nt
  s_add_u32 s9, s8, 458752
  buffer_load_dwordx4 v[96:99], v3, s[48:51], s9 offen offset:2048 nt
  s_add_u32 s9, s8, 458752
  buffer_load_dwordx4 v[100:103], v3, s[48:51], s9 offen offset:3072 nt
  s_add_u32 s9, s8, 491520
  buffer_load_dwordx4 v[104:107], v3, s[48:51], s9 offen offset:0 nt
  s_add_u32 s9, s8, 491520
  buffer_load_dwordx4 v[108:111], v3, s[48:51], s9 offen offset:1024 nt
  s_add_u32 s9, s8, 491520
  buffer_load_dwordx4 v[16:19], v3, s[48:51], s9 offen offset:2048 nt
  s_add_u32 s9, s8, 491520
  buffer_load_dwordx4 v[20:23], v3, s[48:51], s9 offen offset:3072 nt
  v_mfma_f32_16x16x32_bf16 v[220:223], v[144:147], v[236:239], v[220:223]
  v_mfma_f32_16x16x32_bf16 v[224:227], v[144:147], v[240:243], v[224:227]
  s_waitcnt vmcnt(24)
  s_cmp_ge_u32 s3, 4
  s_cbranch_scc1 L_x3_done
  v_max_u32 v4, v244, v245
  v_max3_u32 v4, v4, v246, v247
  v_max3_u32 v4, v4, v248, v249
  v_max3_u32 v4, v4, v250, v251
  v_cmp_eq_u32 vcc, -1, v4
  s_nop 1
  s_cmp_eq_u64 vcc, 0
  s_cbranch_scc1 L_x3_ok
  s_mov_b32 s94, 0
L_poll_8:
  s_nop 7
  buffer_load_dwordx2 v[244:245], v11, s[88:91], s29 offen offset:1024 sc0 sc1
  buffer_load_dwordx2 v[246:247], v11, s[88:91], s29 offen offset:3072 sc0 sc1
  buffer_load_dwordx2 v[248:249], v11, s[88:91], s27 offen offset:1024 sc0 sc1
  buffer_load_dwordx2 v[250:251], v11, s[88:91], s27 offen offset:3072 sc0 sc1
  s_waitcnt vmcnt(0)
  v_max_u32 v4, v244, v245
  v_max3_u32 v4, v4, v246, v247
  v_max3_u32 v4, v4, v248, v249
  v_max3_u32 v4, v4, v250, v251
  v_cmp_eq_u32 vcc, -1, v4
  s_nop 1
  s_cmp_eq_u64 vcc, 0
  s_cbranch_scc1 L_polldone_9
  s_add_u32 s94, s94, 1
  s_cmp_gt_u32 s94, 400000
  s_cbranch_scc1 L_polldone_9
  s_sleep 1
  s_branch L_poll_8
L_polldone_9:
  s_nop 7
L_x3_ok:
  s_nop 7
  v_max3_f32 v192, v244, v246, v248
  v_max_f32 v192, v192, v250
  v_sub_f32 v244, v244, v192
  v_sub_f32 v246, v246, v192
  v_sub_f32 v248, v248, v192
  v_sub_f32 v250, v250, v192
  v_sub_f32 v176, v176, v192
  v_sub_f32 v178, v178, v192
  v_sub_f32 v180, v180, v192
  v_sub_f32 v182, v182, v192
  v_sub_f32 v184, v184, v192
  v_sub_f32 v186, v186, v192
  v_sub_f32 v188, v188, v192
  v_sub_f32 v190, v190, v192
  v_mul_f32 v244, 0x3fb8aa3b, v244
  v_mul_f32 v246, 0x3fb8aa3b, v246
  v_mul_f32 v248, 0x3fb8aa3b, v248
  v_mul_f32 v250, 0x3fb8aa3b, v250
  v_mul_f32 v176, 0x3fb8aa3b, v176
  v_mul_f32 v178, 0x3fb8aa3b, v178
  v_mul_f32 v180, 0x3fb8aa3b, v180
  v_mul_f32 v182, 0x3fb8aa3b, v182
  v_mul_f32 v184, 0x3fb8aa3b, v184
  v_mul_f32 v186, 0x3fb8aa3b, v186
  v_mul_f32 v188, 0x3fb8aa3b, v188
  v_mul_f32 v190, 0x3fb8aa3b, v190
  v_exp_f32 v244, v244
  v_exp_f32 v246, v246
  v_exp_f32 v248, v248
  v_exp_f32 v250, v250
  v_exp_f32 v176, v176
  v_exp_f32 v178, v178
  v_exp_f32 v180, v180
  v_exp_f32 v182, v182
  v_exp_f32 v184, v184
  v_exp_f32 v186, v186
  v_exp_f32 v188, v188
  v_exp_f32 v190, v190
  v_mul_f32 v193, v244, v245
  v_fmac_f32 v193, v246, v247
  v_fmac_f32 v193, v248, v249
  v_fmac_f32 v193, v250, v251
  v_rcp_f32 v5, v193
  s_nop 0
  v_fma_f32 v4, -v5, v193, 1.0
  v_fma_f32 v5, v4, v5, v5
  v_mul_f32 v176, v176, v5
  v_mul_f32 v178, v178, v5
  v_mul_f32 v180, v180, v5
  v_mul_f32 v182, v182, v5
  v_mul_f32 v184, v184, v5
  v_mul_f32 v186, v186, v5
  v_mul_f32 v188, v188, v5
  v_mul_f32 v190, v190, v5
L_x3_done:
  s_nop 7
  s_barrier
  s_waitcnt vmcnt(16)
  v_perm_b32 v228, v28, v24, s10
  v_perm_b32 v229, v36, v32, s10
  v_perm_b32 v230, v44, v40, s10
  v_perm_b32 v231, v52, v48, s10
  v_perm_b32 v232, v28, v24, s11
  v_perm_b32 v233, v36, v32, s11
  v_perm_b32 v234, v44, v40, s11
  v_perm_b32 v235, v52, v48, s11
  v_mfma_f32_16x16x32_bf16 v[196:199], v[152:155], v[228:231], v[196:199]
  s_nop 0
  v_mfma_f32_16x16x32_bf16 v[200:203], v[152:155], v[232:235], v[200:203]
  v_perm_b32 v236, v29, v25, s10
  v_perm_b32 v237, v37, v33, s10
  v_perm_b32 v238, v45, v41, s10
  v_perm_b32 v239, v53, v49, s10
  v_perm_b32 v240, v29, v25, s11
  v_perm_b32 v241, v37, v33, s11
  v_perm_b32 v242, v45, v41, s11
  v_perm_b32 v243, v53, v49, s11
  v_mfma_f32_16x16x32_bf16 v[204:207], v[152:155], v[236:239], v[204:207]
  s_nop 0
  v_mfma_f32_16x16x32_bf16 v[208:211], v[152:155], v[240:243], v[208:211]
  v_perm_b32 v228, v30, v26, s10
  v_perm_b32 v229, v38, v34, s10
  v_perm_b32 v230, v46, v42, s10
  v_perm_b32 v231, v54, v50, s10
  v_perm_b32 v232, v30, v26, s11
  v_perm_b32 v233, v38, v34, s11
  v_perm_b32 v234, v46, v42, s11
  v_perm_b32 v235, v54, v50, s11
  v_mfma_f32_16x16x32_bf16 v[212:215], v[152:155], v[228:231], v[212:215]
  s_nop 0
  v_mfma_f32_16x16x32_bf16 v[216:219], v[152:155], v[232:235], v[216:219]
  v_perm_b32 v236, v31, v27, s10
  v_perm_b32 v237, v39, v35, s10
  v_perm_b32 v238, v47, v43, s10
  v_perm_b32 v239, v55, v51, s10
  v_perm_b32 v240, v31, v27, s11
  v_perm_b32 v241, v39, v35, s11
  v_perm_b32 v242, v47, v43, s11
  v_perm_b32 v243, v55, v51, s11
  v_lshlrev_b32 v5, 2, v1
  buffer_load_dword v13, v5, s[84:87], 0 offen sc0 sc1
  v_mfma_f32_16x16x32_bf16 v[220:223], v[152:155], v[236:239], v[220:223]
  v_mfma_f32_16x16x32_bf16 v[224:227], v[152:155], v[240:243], v[224:227]
  s_barrier
  s_waitcnt vmcnt(9)
  v_perm_b32 v228, v60, v56, s10
  v_perm_b32 v229, v68, v64, s10
  v_perm_b32 v230, v76, v72, s10
  v_perm_b32 v231, v84, v80, s10
  v_perm_b32 v232, v60, v56, s11
  v_perm_b32 v233, v68, v64, s11
  v_perm_b32 v234, v76, v72, s11
  v_perm_b32 v235, v84, v80, s11
  v_mfma_f32_16x16x32_bf16 v[196:199], v[160:163], v[228:231], v[196:199]
  s_nop 0
  v_mfma_f32_16x16x32_bf16 v[200:203], v[160:163], v[232:235], v[200:203]
  v_perm_b32 v236, v61, v57, s10
  v_perm_b32 v237, v69, v65, s10
  v_perm_b32 v238, v77, v73, s10
  v_perm_b32 v239, v85, v81, s10
  v_perm_b32 v240, v61, v57, s11
  v_perm_b32 v241, v69, v65, s11
  v_perm_b32 v242, v77, v73, s11
  v_perm_b32 v243, v85, v81, s11
  v_mfma_f32_16x16x32_bf16 v[204:207], v[160:163], v[236:239], v[204:207]
  s_nop 0
  v_mfma_f32_16x16x32_bf16 v[208:211], v[160:163], v[240:243], v[208:211]
  v_perm_b32 v228, v62, v58, s10
  v_perm_b32 v229, v70, v66, s10
  v_perm_b32 v230, v78, v74, s10
  v_perm_b32 v231, v86, v82, s10
  v_perm_b32 v232, v62, v58, s11
  v_perm_b32 v233, v70, v66, s11
  v_perm_b32 v234, v78, v74, s11
  v_perm_b32 v235, v86, v82, s11
  v_mfma_f32_16x16x32_bf16 v[212:215], v[160:163], v[228:231], v[212:215]
  s_nop 0
  v_mfma_f32_16x16x32_bf16 v[216:219], v[160:163], v[232:235], v[216:219]
  v_perm_b32 v236, v63, v59, s10
  v_perm_b32 v237, v71, v67, s10
  v_perm_b32 v238, v79, v75, s10
  v_perm_b32 v239, v87, v83, s10
  v_perm_b32 v240, v63, v59, s11
  v_perm_b32 v241, v71, v67, s11
  v_perm_b32 v242, v79, v75, s11
  v_perm_b32 v243, v87, v83, s11
  v_mfma_f32_16x16x32_bf16 v[220:223], v[160:163], v[236:239], v[220:223]
  s_nop 0
  v_mfma_f32_16x16x32_bf16 v[224:227], v[160:163], v[240:243], v[224:227]
  s_barrier
  s_waitcnt vmcnt(1)
  v_perm_b32 v228, v92, v88, s10
  v_perm_b32 v229, v100, v96, s10
  v_perm_b32 v230, v108, v104, s10
  v_perm_b32 v231, v20, v16, s10
  v_perm_b32 v232, v92, v88, s11
  v_perm_b32 v233, v100, v96, s11
  v_perm_b32 v234, v108, v104, s11
  v_perm_b32 v235, v20, v16, s11
  v_mfma_f32_16x16x32_bf16 v[196:199], v[168:171], v[228:231], v[196:199]
  s_nop 0
  v_mfma_f32_16x16x32_bf16 v[200:203], v[168:171], v[232:235], v[200:203]
  v_perm_b32 v236, v93, v89, s10
  v_perm_b32 v237, v101, v97, s10
  v_perm_b32 v238, v109, v105, s10
  v_perm_b32 v239, v21, v17, s10
  v_perm_b32 v240, v93, v89, s11
  v_perm_b32 v241, v101, v97, s11
  v_perm_b32 v242, v109, v105, s11
  v_perm_b32 v243, v21, v17, s11
  v_mfma_f32_16x16x32_bf16 v[204:207], v[168:171], v[236:239], v[204:207]
  s_nop 0
  v_mfma_f32_16x16x32_bf16 v[208:211], v[168:171], v[240:243], v[208:211]
  v_perm_b32 v228, v94, v90, s10
  v_perm_b32 v229, v102, v98, s10
  v_perm_b32 v230, v110, v106, s10
  v_perm_b32 v231, v22, v18, s10
  v_perm_b32 v232, v94, v90, s11
  v_perm_b32 v233, v102, v98, s11
  v_perm_b32 v234, v110, v106, s11
  v_perm_b32 v235, v22, v18, s11
  v_mfma_f32_16x16x32_bf16 v[212:215], v[168:171], v[228:231], v[212:215]
  s_nop 0
  v_mfma_f32_16x16x32_bf16 v[216:219], v[168:171], v[232:235], v[216:219]
  v_perm_b32 v236, v95, v91, s10
  v_perm_b32 v237, v103, v99, s10
  v_perm_b32 v238, v111, v107, s10
  v_perm_b32 v239, v23, v19, s10
  v_perm_b32 v240, v95, v91, s11
  v_perm_b32 v241, v103, v99, s11
  v_perm_b32 v242, v111, v107, s11
  v_perm_b32 v243, v23, v19, s11
  v_mfma_f32_16x16x32_bf16 v[220:223], v[168:171], v[236:239], v[220:223]
  s_nop 0
  v_mfma_f32_16x16x32_bf16 v[224:227], v[168:171], v[240:243], v[224:227]
  s_mov_b32 exec_hi, 0
  ds_write2_b32 v6, v196, v200 offset0:0 offset1:8
  ds_write2_b32 v6, v204, v208 offset0:16 offset1:24
  ds_write2_b32 v6, v212, v216 offset0:32 offset1:40
  s_nop 3
  ds_write2_b32 v6, v220, v224 offset0:48 offset1:56
  s_mov_b32 exec_hi, -1
  s_waitcnt vmcnt(0)
  s_waitcnt lgkmcnt(0)
  s_barrier
  s_cmp_ge_u32 s3, 4
  s_cbranch_scc1 L_t3
  ds_read_b32 v228, v8 offset:0
  ds_read_b32 v229, v8 offset:1152
  ds_read_b32 v230, v8 offset:2304
  ds_read_b32 v231, v8 offset:3456
  ds_read_b32 v232, v8 offset:4608
  ds_read_b32 v233, v8 offset:5760
  ds_read_b32 v234, v8 offset:6912
  ds_read_b32 v235, v8 offset:8064
  s_waitcnt lgkmcnt(6)
  v_mul_f32 v4, v228, v176
  v_mul_f32 v5, v229, v178
  s_waitcnt lgkmcnt(4)
  v_fmac_f32 v4, v230, v180
  v_fmac_f32 v5, v231, v182
  s_waitcnt lgkmcnt(2)
  v_fmac_f32 v4, v232, v184
  v_fmac_f32 v5, v233, v186
  s_waitcnt lgkmcnt(0)
  v_fmac_f32 v4, v234, v188
  v_fmac_f32 v5, v235, v190
  v_add_f32 v4, v4, v5
  buffer_store_dword v4, v9, s[88:91], s28 offen sc0 sc1
L_t3:
  s_nop 7
  s_cmp_lg_u32 s3, 0
  s_cbranch_scc1 L_t3_done
  s_mov_b32 s94, 0
  buffer_load_dwordx4 v[32:35], v10, s[88:91], s30 offen sc0 sc1
  buffer_load_dwordx4 v[36:39], v10, s[88:91], s30 offen offset:16 sc0 sc1
  s_sleep 8
  buffer_load_dwordx4 v[40:43], v10, s[88:91], s30 offen sc0 sc1
  buffer_load_dwordx4 v[44:47], v10, s[88:91], s30 offen offset:16 sc0 sc1
L_pp_10:
  s_nop 7
  s_waitcnt vmcnt(2)
  v_max_u32 v4, v32, v33
  v_max3_u32 v4, v4, v34, v35
  v_max3_u32 v4, v4, v36, v37
  v_max3_u32 v4, v4, v38, v39
  v_cmp_eq_u32 vcc, -1, v4
  s_nop 1
  s_cmp_eq_u64 vcc, 0
  s_cbranch_scc1 L_ppA_11
  buffer_load_dwordx4 v[32:35], v10, s[88:91], s30 offen sc0 sc1
  buffer_load_dwordx4 v[36:39], v10, s[88:91], s30 offen offset:16 sc0 sc1
  s_waitcnt vmcnt(2)
  v_max_u32 v4, v40, v41
  v_max3_u32 v4, v4, v42, v43
  v_max3_u32 v4, v4, v44, v45
  v_max3_u32 v4, v4, v46, v47
  v_cmp_eq_u32 vcc, -1, v4
  s_nop 1
  s_cmp_eq_u64 vcc, 0
  s_cbranch_scc1 L_ppB_12
  buffer_load_dwordx4 v[40:43], v10, s[88:91], s30 offen sc0 sc1
  buffer_load_dwordx4 v[44:47], v10, s[88:91], s30 offen offset:16 sc0 sc1
  s_add_u32 s94, s94, 1
  s_cmp_lt_u32 s94, 400000
  s_cbranch_scc1 L_pp_10
  s_waitcnt vmcnt(0)
L_ppB_12:
  s_nop 7
  v_add_f32_dpp v40, v40, v40 quad_perm:[1,0,3,2] row_mask:0xf bank_mask:0xf
  v_add_f32_dpp v41, v41, v41 quad_perm:[1,0,3,2] row_mask:0xf bank_mask:0xf
  v_add_f32_dpp v42, v42, v42 quad_perm:[1,0,3,2] row_mask:0xf bank_mask:0xf
  v_add_f32_dpp v43, v43, v43 quad_perm:[1,0,3,2] row_mask:0xf bank_mask:0xf
  v_add_f32_dpp v44, v44, v44 quad_perm:[1,0,3,2] row_mask:0xf bank_mask:0xf
  v_add_f32_dpp v45, v45, v45 quad_perm:[1,0,3,2] row_mask:0xf bank_mask:0xf
  v_add_f32_dpp v46, v46, v46 quad_perm:[1,0,3,2] row_mask:0xf bank_mask:0xf
  v_add_f32_dpp v47, v47, v47 quad_perm:[1,0,3,2] row_mask:0xf bank_mask:0xf
  v_add_f32_dpp v40, v40, v40 quad_perm:[2,3,0,1] row_mask:0xf bank_mask:0xf
  v_add_f32_dpp v41, v41, v41 quad_perm:[2,3,0,1] row_mask:0xf bank_mask:0xf
  v_add_f32_dpp v42, v42, v42 quad_perm:[2,3,0,1] row_mask:0xf bank_mask:0xf
  v_add_f32_dpp v43, v43, v43 quad_perm:[2,3,0,1] row_mask:0xf bank_mask:0xf
  v_add_f32_dpp v44, v44, v44 quad_perm:[2,3,0,1] row_mask:0xf bank_mask:0xf
  v_add_f32_dpp v45, v45, v45 quad_perm:[2,3,0,1] row_mask:0xf bank_mask:0xf
  v_add_f32_dpp v46, v46, v46 quad_perm:[2,3,0,1] row_mask:0xf bank_mask:0xf
  v_add_f32_dpp v47, v47, v47 quad_perm:[2,3,0,1] row_mask:0xf bank_mask:0xf
  v_cvt_pk_bf16_f32 v48, v40, v41
  v_cvt_pk_bf16_f32 v49, v42, v43
  v_cvt_pk_bf16_f32 v50, v44, v45
  v_cvt_pk_bf16_f32 v51, v46, v47
  s_branch L_ppE_13
L_ppA_11:
  s_nop 7
  v_add_f32_dpp v32, v32, v32 quad_perm:[1,0,3,2] row_mask:0xf bank_mask:0xf
  v_add_f32_dpp v33, v33, v33 quad_perm:[1,0,3,2] row_mask:0xf bank_mask:0xf
  v_add_f32_dpp v34, v34, v34 quad_perm:[1,0,3,2] row_mask:0xf bank_mask:0xf
  v_add_f32_dpp v35, v35, v35 quad_perm:[1,0,3,2] row_mask:0xf bank_mask:0xf
  v_add_f32_dpp v36, v36, v36 quad_perm:[1,0,3,2] row_mask:0xf bank_mask:0xf
  v_add_f32_dpp v37, v37, v37 quad_perm:[1,0,3,2] row_mask:0xf bank_mask:0xf
  v_add_f32_dpp v38, v38, v38 quad_perm:[1,0,3,2] row_mask:0xf bank_mask:0xf
  v_add_f32_dpp v39, v39, v39 quad_perm:[1,0,3,2] row_mask:0xf bank_mask:0xf
  v_add_f32_dpp v32, v32, v32 quad_perm:[2,3,0,1] row_mask:0xf bank_mask:0xf
  v_add_f32_dpp v33, v33, v33 quad_perm:[2,3,0,1] row_mask:0xf bank_mask:0xf
  v_add_f32_dpp v34, v34, v34 quad_perm:[2,3,0,1] row_mask:0xf bank_mask:0xf
  v_add_f32_dpp v35, v35, v35 quad_perm:[2,3,0,1] row_mask:0xf bank_mask:0xf
  v_add_f32_dpp v36, v36, v36 quad_perm:[2,3,0,1] row_mask:0xf bank_mask:0xf
  v_add_f32_dpp v37, v37, v37 quad_perm:[2,3,0,1] row_mask:0xf bank_mask:0xf
  v_add_f32_dpp v38, v38, v38 quad_perm:[2,3,0,1] row_mask:0xf bank_mask:0xf
  v_add_f32_dpp v39, v39, v39 quad_perm:[2,3,0,1] row_mask:0xf bank_mask:0xf
  v_cvt_pk_bf16_f32 v48, v32, v33
  v_cvt_pk_bf16_f32 v49, v34, v35
  v_cvt_pk_bf16_f32 v50, v36, v37
  v_cvt_pk_bf16_f32 v51, v38, v39
L_ppE_13:
  s_nop 7
  ds_write_b128 v195, v[48:51]
L_t3_done:
  s_nop 7
  s_waitcnt lgkmcnt(0)
  s_barrier
  ds_read_b128 v[48:51], v12
  ds_read_b128 v[52:55], v12 offset:64
  s_waitcnt lgkmcnt(0)
  v_mfma_f32_16x16x32_bf16 v[196:199], v[48:51], v[116:119], 0
  v_mfma_f32_16x16x32_bf16 v[200:203], v[48:51], v[132:135], 0
  v_mfma_f32_16x16x32_bf16 v[204:207], v[48:51], v[148:151], 0
  v_mfma_f32_16x16x32_bf16 v[208:211], v[48:51], v[164:167], 0
  v_mfma_f32_16x16x32_bf16 v[196:199], v[52:55], v[124:127], v[196:199]
  v_mfma_f32_16x16x32_bf16 v[200:203], v[52:55], v[140:143], v[200:203]
  v_mfma_f32_16x16x32_bf16 v[204:207], v[52:55], v[156:159], v[204:207]
  v_mfma_f32_16x16x32_bf16 v[208:211], v[52:55], v[172:175], v[208:211]
  s_mov_b64 exec, 0xffff
  s_nop 3
  buffer_store_dword v196, v7, s[88:91], s31 offen offset:0 sc0 sc1
  buffer_store_dword v200, v7, s[88:91], s31 offen offset:512 sc0 sc1
  buffer_store_dword v204, v7, s[88:91], s31 offen offset:1024 sc0 sc1
  buffer_store_dword v208, v7, s[88:91], s31 offen offset:1536 sc0 sc1
  s_mov_b64 exec, -1
  s_cmp_ge_u32 s3, 4
  s_cbranch_scc1 L_proj_done
  v_mfma_f32_16x16x32_bf16 v[212:215], v[48:51], v[112:115], 0
  v_mfma_f32_16x16x32_bf16 v[212:215], v[52:55], v[120:123], v[212:215]
  s_mov_b64 exec, 0xffff
  s_nop 6
  buffer_store_dword v212, v7, s[88:91], s31 offen offset:2048 sc0 sc1
  s_mov_b64 exec, -1
L_proj_done:
  s_nop 7
  s_cmp_ge_u32 s7, 18
  s_cbranch_scc1 L_end
  v_cmp_eq_u32 vcc, 0x01010101, v13
  s_nop 1
  s_cmp_eq_u64 vcc, -1
  s_cbranch_scc1 L_all_ok
  v_lshlrev_b32 v5, 2, v1
  s_mov_b32 s94, 0
L_poll_14:
  s_nop 7
  buffer_load_dword v13, v5, s[84:87], 0 offen sc0 sc1
  s_waitcnt vmcnt(0)
  v_cmp_eq_u32 vcc, 0x01010101, v13
  s_nop 1
  s_cmp_eq_u64 vcc, -1
  s_cbranch_scc1 L_polldone_15
  s_add_u32 s94, s94, 1
  s_cmp_gt_u32 s94, 400000
  s_cbranch_scc1 L_polldone_15
  s_sleep 1
  s_branch L_poll_14
L_polldone_15:
  s_nop 7
L_all_ok:
  s_nop 7
  v_lshrrev_b32 v4, 3, v0
  v_mul_u32_u24 v4, 2304, v4
  v_and_b32 v5, 7, v0
  v_lshl_add_u32 v4, v5, 4, v4
  s_mul_i32 s9, s5, 147456
  s_lshl_b32 s95, s7, 7
  s_add_u32 s9, s9, s95
  s_add_u32 s9, s9, 1048576
  v_and_b32 v6, 31, v1
  s_mul_i32 s92, s5, 576
  s_lshl_b32 s95, s7, 5
  s_add_u32 s92, s92, s95
  s_lshl_b32 s95, s92, 2
  s_add_u32 s95, s95, 1703936
  v_lshlrev_b32 v8, 2, v6
  s_lshl_b32 s92, s92, 1
  v_lshlrev_b32 v7, 1, v6
  buffer_load_ushort v11, v7, s[52:55], s92 offen
  v_mov_b32 v5, 96256
  v_lshl_add_u32 v9, v0, 4, v5
  s_mov_b32 s94, 0
  buffer_load_dwordx4 v[16:19], v4, s[88:91], s9 offen sc0 sc1
  buffer_load_dword v20, v8, s[88:91], s95 offen sc0 sc1
  s_sleep 8
  buffer_load_dwordx4 v[24:27], v4, s[88:91], s9 offen sc0 sc1
  buffer_load_dword v28, v8, s[88:91], s95 offen sc0 sc1
L_pp_16:
  s_nop 7
  s_waitcnt vmcnt(2)
  v_max_u32 v5, v16, v17
  v_max3_u32 v5, v5, v18, v19
  v_max_u32 v5, v5, v20
  v_cmp_eq_u32 vcc, -1, v5
  s_nop 1
  s_cmp_eq_u64 vcc, 0
  s_cbranch_scc1 L_ppA_17
  buffer_load_dwordx4 v[16:19], v4, s[88:91], s9 offen sc0 sc1
  buffer_load_dword v20, v8, s[88:91], s95 offen sc0 sc1
  s_waitcnt vmcnt(2)
  v_max_u32 v5, v24, v25
  v_max3_u32 v5, v5, v26, v27
  v_max_u32 v5, v5, v28
  v_cmp_eq_u32 vcc, -1, v5
  s_nop 1
  s_cmp_eq_u64 vcc, 0
  s_cbranch_scc1 L_ppB_18
  buffer_load_dwordx4 v[24:27], v4, s[88:91], s9 offen sc0 sc1
  buffer_load_dword v28, v8, s[88:91], s95 offen sc0 sc1
  s_add_u32 s94, s94, 1
  s_cmp_lt_u32 s94, 400000
  s_cbranch_scc1 L_pp_16
  s_waitcnt vmcnt(0)
L_ppB_18:
  s_nop 7
  ds_write_b128 v9, v[24:27]
  v_mov_b32 v10, v28
  s_branch L_ppE_19
L_ppA_17:
  s_nop 7
  ds_write_b128 v9, v[16:19]
  v_mov_b32 v10, v20
L_ppE_19:
  s_nop 7
  s_waitcnt lgkmcnt(0)
  s_barrier
  s_cmp_lg_u32 s3, 0
  s_cbranch_scc1 L_end
  v_lshrrev_b32 v4, 5, v1
  v_lshlrev_b32 v4, 12, v4
  v_lshl_add_u32 v4, v6, 2, v4
  v_add_u32 v4, 96256, v4
  ds_read_b32 v112, v4 offset:0
  ds_read_b32 v113, v4 offset:128
  ds_read_b32 v114, v4 offset:256
  ds_read_b32 v115, v4 offset:384
  ds_read_b32 v116, v4 offset:512
  ds_read_b32 v117, v4 offset:640
  ds_read_b32 v118, v4 offset:768
  ds_read_b32 v119, v4 offset:896
  ds_read_b32 v120, v4 offset:1024
  ds_read_b32 v121, v4 offset:1152
  ds_read_b32 v122, v4 offset:1280
  ds_read_b32 v123, v4 offset:1408
  ds_read_b32 v124, v4 offset:1536
  ds_read_b32 v125, v4 offset:1664
  ds_read_b32 v126, v4 offset:1792
  ds_read_b32 v127, v4 offset:1920
  ds_read_b32 v128, v4 offset:2048
  ds_read_b32 v129, v4 offset:2176
  ds_read_b32 v130, v4 offset:2304
  ds_read_b32 v131, v4 offset:2432
  ds_read_b32 v132, v4 offset:2560
  ds_read_b32 v133, v4 offset:2688
  ds_read_b32 v134, v4 offset:2816
  ds_read_b32 v135, v4 offset:2944
  ds_read_b32 v136, v4 offset:3072
  ds_read_b32 v137, v4 offset:3200
  ds_read_b32 v138, v4 offset:3328
  ds_read_b32 v139, v4 offset:3456
  ds_read_b32 v140, v4 offset:3584
  ds_read_b32 v141, v4 offset:3712
  ds_read_b32 v142, v4 offset:3840
  ds_read_b32 v143, v4 offset:3968
  s_waitcnt lgkmcnt(0)
  v_add_f32 v112, v112, v128
  v_add_f32 v113, v113, v129
  v_add_f32 v114, v114, v130
  v_add_f32 v115, v115, v131
  v_add_f32 v116, v116, v132
  v_add_f32 v117, v117, v133
  v_add_f32 v118, v118, v134
  v_add_f32 v119, v119, v135
  v_add_f32 v120, v120, v136
  v_add_f32 v121, v121, v137
  v_add_f32 v122, v122, v138
  v_add_f32 v123, v123, v139
  v_add_f32 v124, v124, v140
  v_add_f32 v125, v125, v141
  v_add_f32 v126, v126, v142
  v_add_f32 v127, v127, v143
  v_add_f32 v112, v112, v120
  v_add_f32 v113, v113, v121
  v_add_f32 v114, v114, v122
  v_add_f32 v115, v115, v123
  v_add_f32 v116, v116, v124
  v_add_f32 v117, v117, v125
  v_add_f32 v118, v118, v126
  v_add_f32 v119, v119, v127
  v_add_f32 v112, v112, v116
  v_add_f32 v113, v113, v117
  v_add_f32 v114, v114, v118
  v_add_f32 v115, v115, v119
  v_add_f32 v112, v112, v114
  v_add_f32 v113, v113, v115
  v_add_f32 v112, v112, v113
  v_mov_b32 v8, v112
  s_nop 1
  v_permlane32_swap_b32 v8, v112
  v_add_f32 v8, v8, v112
  v_cvt_pk_bf16_f32 v8, v8, v8
  v_lshlrev_b32 v8, 16, v8
  v_mul_f32 v8, v8, v10
  v_cvt_pk_bf16_f32 v8, v8, v8
  v_lshlrev_b32 v8, 16, v8
  v_lshlrev_b32 v11, 16, v11
  v_add_f32 v8, v8, v11
  v_cvt_pk_bf16_f32 v8, v8, v8
  s_mov_b32 exec_hi, 0
  buffer_store_short v8, v7, s[80:83], s92 offen
  s_mov_b64 exec, -1
L_end:
  s_nop 7
L_exit:
  s_endpgm
.section .rodata,"a"
.p2align 6
.amdhsa_kernel recurrent_scan__gqa_block_cached__mixer_token_mlp__decode_kernel
  .amdhsa_next_free_vgpr 252
  .amdhsa_next_free_sgpr 102
  .amdhsa_accum_offset 252
  .amdhsa_group_segment_fixed_size 0
  .amdhsa_kernarg_size 104
  .amdhsa_user_sgpr_count 2
  .amdhsa_user_sgpr_kernarg_segment_ptr 1
  .amdhsa_system_sgpr_workgroup_id_x 1
.end_amdhsa_kernel
```
